```python
import torch

def _softmax(x, axis=-1):
    return torch.softmax(x, dim=axis)
def _gelu(x):
    return torch.nn.functional.gelu(x, approximate="tanh")
def _silu(x):
    return torch.nn.functional.silu(x)
def _sigmoid(x):
    return torch.sigmoid(x)
def _layernorm(x, axis=-1, eps=1e-5):
    m = x.mean(dim=axis, keepdim=True)
    v = x.var(dim=axis, keepdim=True, unbiased=False)
    return (x - m) / torch.sqrt(v + eps)
def _scatter_add(tgt, idx, src, axis=0):
    return tgt.clone().index_add_(axis, idx, src)
def _segment_sum(src, seg, n):
    out = torch.zeros((n,) + src.shape[1:], dtype=src.dtype)
    return out.index_add_(0, seg, src)
def _pad(x, pw):
    flat = tuple(v for pair in reversed(pw) for v in pair)
    return torch.nn.functional.pad(x, flat)

kernel_name = 'recurrent_scan__ssm_conv_s4d__dense_activation_squared_relu__prompt'

def setup_inputs():

    _w = (lambda a: (lambda t: t.to(torch.bfloat16) if t.is_floating_point() else t)(torch.as_tensor(a)))
    def _A_setup():
        Bsz, L, D, N = 1, 2048, 640, 192
        return {
            "u": _w((lambda *s: torch.randn(*s, dtype=torch.bfloat16) * 0.05)(Bsz, L, D)),
            "log_A_real": _w((lambda *s: torch.randn(*s, dtype=torch.bfloat16) * 3.2)(D, N) * 0.5),
            "A_imag": _w((lambda *s: torch.randn(*s, dtype=torch.bfloat16) * 0.05)(D, N) * 3.14),
            "C_real": _w((lambda *s: torch.randn(*s, dtype=torch.bfloat16) * 0.2)(D, N) / N ** 0.5),
            "C_imag": _w((lambda *s: torch.randn(*s, dtype=torch.bfloat16) * 0.2)(D, N) / N ** 0.5),
            "log_dt": _w((lambda *s: torch.randn(*s, dtype=torch.bfloat16) * 0.05)(D) * 0.5 - 4.0),
            "D_skip": _w((lambda *s: torch.randn(*s, dtype=torch.bfloat16) * 0.05)(D)),
        }
    _A_in = _A_setup()

    def _B_setup():
        B, S, D, F = 1, 2048, 640, 1536
        return {
            "x": _w((lambda *s: torch.randn(*s, dtype=torch.bfloat16) * 0.05)(B, S, D)),
            "w1": _w((lambda *s: torch.randn(*s, dtype=torch.bfloat16) * 0.05)(D, F)),
            "b1": _w((lambda *s: torch.randn(*s, dtype=torch.bfloat16) * 0.4)(F)),
            "w2": _w((lambda *s: torch.randn(*s, dtype=torch.bfloat16) * 0.05)(F, D)),
            "b2": _w((lambda *s: torch.randn(*s, dtype=torch.bfloat16) * 1.6)(D)),
        }
    _B_in = _B_setup()

    return {
        "A_u": _A_in["u"],
        "A_log_A_real": _A_in["log_A_real"],
        "A_A_imag": _A_in["A_imag"],
        "A_C_real": _A_in["C_real"],
        "A_C_imag": _A_in["C_imag"],
        "A_log_dt": _A_in["log_dt"],
        "A_D_skip": _A_in["D_skip"],
        "B_x": _B_in["x"],
        "B_w1": _B_in["w1"],
        "B_b1": _B_in["b1"],
        "B_w2": _B_in["w2"],
        "B_b2": _B_in["b2"],
    }

def reference(A_u, A_log_A_real, A_A_imag, A_C_real, A_C_imag, A_log_dt, A_D_skip, B_x, B_w1, B_b1, B_w2, B_b2):
    def _A_ref(u, log_A_real, A_imag, C_real, C_imag, log_dt, D_skip):
        L = u.shape[1]
        dt = torch.exp(log_dt)
        A = -torch.exp(log_A_real) + 1j * A_imag
        C = (C_real + 1j * C_imag) * dt[:, None]
        pos = (lambda x, dt: x.to(dt))(torch.arange(L), log_dt.dtype)
        P = torch.exp((A * dt[:, None])[:, :, None] * pos[None, None, :])
        K = 2.0 * torch.einsum("dn,dnl->dl", C, P).real
        L2 = 2 * L
        u_t = (lambda x, *d: x.permute(*d))(u, 0, 2, 1)
        Kf = (lambda x, *a, **k: torch.fft.rfft(x.float(), *a, **k))(K, L2)
        Uf = (lambda x, *a, **k: torch.fft.rfft(x.float(), *a, **k))(u_t, L2)
        y = (lambda x, *a, **k: torch.fft.irfft(x, *a, **k).to(torch.bfloat16))(Uf * Kf[None, :, :], L2)[:, :, :L]
        y = (lambda x, *d: x.permute(*d))(y, 0, 2, 1)
        return y + u * D_skip[None, None, :]

    def _B_ref(x, w1, b1, w2, b2):
        h = torch.einsum("bsd,df->bsf", x, w1) + b1
        zero = torch.zeros_like(h)
        r = torch.where(h > zero, h, zero)
        h = r * r
        out = torch.einsum("bsf,fd->bsd", h, w2) + b2
        return out

    x = A_u
    xn = _layernorm(x, axis=-1)
    s = _A_ref(xn, A_log_A_real, A_A_imag, A_C_real, A_C_imag, A_log_dt, A_D_skip)
    g = _silu(_B_ref(xn, B_w1, B_b1, B_w2, B_b2))
    return x + s * g
```

```asm
; @launch grid=(256,1,1) block=(512,1,1) lds=163840
.amdgcn_target "amdgcn-amd-amdhsa--gfx950"
.text
.globl recurrent_scan__ssm_conv_s4d__dense_activation_squared_relu__prompt_kernel
.p2align 8
.type recurrent_scan__ssm_conv_s4d__dense_activation_squared_relu__prompt_kernel,@function
recurrent_scan__ssm_conv_s4d__dense_activation_squared_relu__prompt_kernel:
fused_start:
    s_load_dwordx16 s[4:19], s[0:1], 0
    s_load_dwordx8 s[20:27], s[0:1], 64
    s_load_dwordx4 s[28:31], s[0:1], 96
    s_load_dwordx2 s[32:33], s[0:1], 112
    s_memrealtime s[94:95]
    s_cmp_ge_u32 s2, 256
    s_cbranch_scc1 fused_end
    v_lshrrev_b32 v1, 6, v0
    v_and_b32 v0, 63, v0
    s_and_b32 s35, s2, 7
    v_readfirstlane_b32 s34, v1
    s_lshr_b32 s36, s2, 3
    s_getpc_b64 s[62:63]
fused_pc:
    s_cmp_lg_u32 s34, 7
    s_cbranch_scc1 fused_nopf
    s_and_b32 s60, s36, 7
    s_mul_i32 s60, s60, 4352
    v_lshlrev_b32 v2, 7, v0
    v_add_u32 v2, s60, v2
    v_min_u32 v2, fused_end-fused_pc, v2
    s_mov_b32 exec_hi, 3
    global_load_dword v130, v2, s[62:63]
    s_mov_b32 exec_hi, -1
fused_nopf:
    s_and_b32 s60, s35, 3
    s_lshl_b32 s60, s60, 2
    s_and_b32 s61, s36, 3
    s_add_u32 s37, s60, s61
    s_lshr_b32 s60, s35, 2
    s_lshl_b32 s60, s60, 3
    s_lshr_b32 s40, s36, 2
    s_add_u32 s38, s60, s40
    s_lshl_b32 s60, s35, 2
    s_add_u32 s39, s60, s61
    s_mul_i32 s60, s36, 43
    s_lshr_b32 s60, s60, 7
    s_mul_i32 s61, s60, 3
    s_sub_u32 s61, s36, s61
    s_mul_i32 s62, s35, 80
    s_lshl_b32 s63, s60, 3
    s_add_u32 s62, s62, s63
    s_mul_i32 s63, s61, 3
    s_add_u32 s42, s62, s63
    s_cmp_eq_u32 s61, 2
    s_cselect_b32 s41, 2, 3
    s_cmp_ge_u32 s36, 30
    s_cselect_b32 s41, 0, s41
    s_sub_u32 s61, s36, 20
    s_cmp_ge_u32 s36, 30
    s_cselect_b32 s60, s61, s60
    s_mul_i32 s61, s35, 12
    s_add_u32 s43, s61, s60
    s_lshl_b32 s93, s37, 4
    s_add_u32 s93, s93, s38
    v_lshlrev_b32 v2, 3, v0
    v_add_u32 v2, 161568, v2
    v_mov_b32 v4, 0
    v_mov_b32 v5, 0
    ds_write_b64 v2, v[4:5]
    s_cmp_eq_u32 s34, 7
    s_cselect_b32 s60, s2, 1
    s_cmp_lg_u32 s60, 0
    s_waitcnt lgkmcnt(0)
    s_cbranch_scc1 fused_nonce0
    s_or_b32 s61, s94, 1
    v_mov_b32 v2, s61
    s_mov_b64 exec, 1
    global_store_dword v4, v2, s[30:31] sc1
    s_mov_b64 exec, -1
fused_nonce0:
    s_barrier
    s_mov_b32 s44, s32
    s_and_b32 s45, s33, 0xffff
    s_mov_b32 s46, 17825792
    s_mov_b32 s47, 0x00020000
    s_mov_b32 s48, s4
    s_and_b32 s49, s5, 0xffff
    s_mov_b32 s50, 2621440
    s_mov_b32 s51, 0x00020000
    s_cmp_ge_u32 s34, 4
    s_cbranch_scc1 fused_aux0
    s_setprio 2
    s_lshl_b32 s60, s93, 3
    s_lshl_b32 s61, s34, 1
    s_add_u32 s60, s60, s61
    s_mul_i32 s60, s60, 1280
    v_lshrrev_b32 v2, 5, v0
    v_and_b32 v3, 31, v0
    v_mul_u32_u24 v1, 1280, v2
    v_lshl_add_u32 v1, v3, 3, v1
    buffer_load_dwordx2 v[100:101], v1, s[48:51], s60 offen offset:0
    buffer_load_dwordx2 v[102:103], v1, s[48:51], s60 offen offset:256
    buffer_load_dwordx2 v[104:105], v1, s[48:51], s60 offen offset:512
    buffer_load_dwordx2 v[106:107], v1, s[48:51], s60 offen offset:768
    buffer_load_dwordx2 v[108:109], v1, s[48:51], s60 offen offset:1024
    s_branch fused_gemm
fused_aux0:
    s_sub_u32 s60, s34, 4
    s_cmp_ge_u32 s60, s41
    s_cbranch_scc1 fused_aux1
    s_setprio 3
    s_sub_u32 s70, s34, 4
    s_add_u32 s71, s42, s70
    s_mul_i32 s60, s71, 384
    v_lshlrev_b32 v2, 2, v0
    v_add_u32 v2, s60, v2
    v_lshlrev_b32 v3, 1, v0
    v_add_u32 v3, s60, v3
    global_load_dword v44, v2, s[6:7]
    global_load_dword v45, v2, s[8:9]
    global_load_dword v46, v2, s[10:11]
    global_load_dword v47, v2, s[12:13]
    s_lshl_b32 s60, s71, 1
    s_and_b32 s60, s60, -4
    s_load_dword s74, s[14:15], s60
    s_load_dword s75, s[16:17], s60
    global_load_ushort v48, v3, s[6:7] offset:256
    global_load_ushort v49, v3, s[8:9] offset:256
    global_load_ushort v50, v3, s[10:11] offset:256
    global_load_ushort v51, v3, s[12:13] offset:256
    s_branch fused_kg
fused_aux1:
    s_cmp_lg_u32 s34, 7
    s_cbranch_scc1 fused_noch
    s_setprio 1
    s_mov_b32 s52, s20
    s_and_b32 s53, s21, 0xffff
    s_mov_b32 s54, 1966080
    s_mov_b32 s55, 0x00020000
    v_add_u32 v5, 0, v0
    v_mul_u32_u24 v6, 43691, v5
    v_lshrrev_b32 v6, 19, v6
    v_mul_u32_u24 v7, 12, v6
    v_sub_u32 v7, v5, v7
    v_lshrrev_b32 v8, 2, v6
    v_and_b32 v8, 2, v8
    v_xor_b32 v7, v7, v8
    v_mul_u32_u24 v6, 3072, v6
    v_lshl_add_u32 v12, v7, 4, v6
    v_add_u32 v5, 64, v0
    v_mul_u32_u24 v6, 43691, v5
    v_lshrrev_b32 v6, 19, v6
    v_mul_u32_u24 v7, 12, v6
    v_sub_u32 v7, v5, v7
    v_lshrrev_b32 v8, 2, v6
    v_and_b32 v8, 2, v8
    v_xor_b32 v7, v7, v8
    v_mul_u32_u24 v6, 3072, v6
    v_lshl_add_u32 v13, v7, 4, v6
    v_add_u32 v5, 128, v0
    v_mul_u32_u24 v6, 43691, v5
    v_lshrrev_b32 v6, 19, v6
    v_mul_u32_u24 v7, 12, v6
    v_sub_u32 v7, v5, v7
    v_lshrrev_b32 v8, 2, v6
    v_and_b32 v8, 2, v8
    v_xor_b32 v7, v7, v8
    v_mul_u32_u24 v6, 3072, v6
    v_lshl_add_u32 v14, v7, 4, v6
    s_mul_i32 s69, s38, 192
    s_cmp_lt_u32 s41, 3
    s_cselect_b32 s66, 24, 36
    s_mul_i32 s68, s37, s66
    s_lshr_b32 s68, s68, 4
    s_mov_b32 s67, s66
    s_sub_u32 s65, s66, 1
fused_sdl:
    s_mul_i32 s63, s68, 49152
    s_add_u32 s63, s63, s69
    s_mul_i32 m0, s68, 3072
    s_nop 0
    buffer_load_dwordx4 v12, s[52:55], s63 offen lds
    s_add_u32 m0, m0, 1024
    s_nop 0
    buffer_load_dwordx4 v13, s[52:55], s63 offen lds
    s_add_u32 m0, m0, 1024
    s_nop 0
    buffer_load_dwordx4 v14, s[52:55], s63 offen lds
    s_add_u32 s68, s68, 1
    s_cmp_eq_u32 s68, s66
    s_cselect_b32 s68, 0, s68
    s_cmp_lg_u32 s67, s65
    s_cbranch_scc1 fused_sdw
    s_mov_b32 s56, s28
    s_and_b32 s57, s29, 0xffff
    s_mov_b32 s58, 2621440
    s_mov_b32 s59, 0x00020000
    v_lshlrev_b32 v3, 20, v0
    s_mov_b32 exec_hi, 0
    buffer_load_dword v131, v3, s[44:47], 0 offen
    buffer_load_dword v132, v3, s[56:59], 0 offen
    s_mov_b64 exec, -1
fused_sdw:
    s_sub_u32 s67, s67, 1
    s_cmp_lg_u32 s67, 0
    s_waitcnt vmcnt(20)
    s_cbranch_scc1 fused_sdl
    s_branch fused_svc
fused_gemm:
    s_mov_b32 s52, s20
    s_and_b32 s53, s21, 0xffff
    s_mov_b32 s54, 1966080
    s_mov_b32 s55, 0x00020000
    v_add_u32 v5, 0, v0
    v_mul_u32_u24 v6, 43691, v5
    v_lshrrev_b32 v6, 19, v6
    v_mul_u32_u24 v7, 12, v6
    v_sub_u32 v7, v5, v7
    v_lshrrev_b32 v8, 2, v6
    v_and_b32 v8, 2, v8
    v_xor_b32 v7, v7, v8
    v_mul_u32_u24 v6, 3072, v6
    v_lshl_add_u32 v92, v7, 4, v6
    v_add_u32 v5, 64, v0
    v_mul_u32_u24 v6, 43691, v5
    v_lshrrev_b32 v6, 19, v6
    v_mul_u32_u24 v7, 12, v6
    v_sub_u32 v7, v5, v7
    v_lshrrev_b32 v8, 2, v6
    v_and_b32 v8, 2, v8
    v_xor_b32 v7, v7, v8
    v_mul_u32_u24 v6, 3072, v6
    v_lshl_add_u32 v93, v7, 4, v6
    v_add_u32 v5, 128, v0
    v_mul_u32_u24 v6, 43691, v5
    v_lshrrev_b32 v6, 19, v6
    v_mul_u32_u24 v7, 12, v6
    v_sub_u32 v7, v5, v7
    v_lshrrev_b32 v8, 2, v6
    v_and_b32 v8, 2, v8
    v_xor_b32 v7, v7, v8
    v_mul_u32_u24 v6, 3072, v6
    v_lshl_add_u32 v94, v7, 4, v6
    s_mul_i32 s69, s38, 192
    v_lshrrev_b32 v5, 4, v0
    v_lshlrev_b32 v5, 3, v5
    s_mul_i32 s60, s38, 192
    v_add_u32 v5, s60, v5
    global_load_dwordx2 v[64:65], v5, s[22:23] offset:0
    global_load_dwordx2 v[66:67], v5, s[22:23] offset:32
    global_load_dwordx2 v[68:69], v5, s[22:23] offset:64
    global_load_dwordx2 v[70:71], v5, s[22:23] offset:96
    global_load_dwordx2 v[72:73], v5, s[22:23] offset:128
    global_load_dwordx2 v[74:75], v5, s[22:23] offset:160
    s_add_u32 s68, s34, 36
    s_mul_i32 s63, s68, 49152
    s_add_u32 s63, s63, s69
    s_mul_i32 m0, s68, 3072
    s_nop 0
    buffer_load_dwordx4 v92, s[52:55], s63 offen lds
    s_add_u32 m0, m0, 1024
    s_nop 0
    buffer_load_dwordx4 v93, s[52:55], s63 offen lds
    s_add_u32 m0, m0, 1024
    s_nop 0
    buffer_load_dwordx4 v94, s[52:55], s63 offen lds
    s_mov_b32 s84, s34
    s_mov_b32 s97, 9008
    s_mov_b32 s61, 131680
    s_lshl_b32 s60, s34, 1
    v_lshrrev_b32 v2, 5, v0
    v_add_u32 v2, s60, v2
    v_mul_u32_u24 v5, 11, v2
    v_lshrrev_b32 v5, 5, v5
    v_mul_u32_u24 v98, 1296, v2
    v_mad_u32_u24 v98, v5, s97, v98
    v_lshrrev_b32 v5, 1, v5
    v_mul_u32_u24 v5, 1440, v5
    v_add3_u32 v98, v98, v5, s61
    v_and_b32 v3, 31, v0
    v_lshl_add_u32 v98, v3, 3, v98
    s_lshl_b32 s60, s84, 7
    s_add_u32 s61, s61, s60
    v_and_b32 v1, 7, v0
    v_mul_u32_u24 v5, 11, v1
    v_lshrrev_b32 v5, 5, v5
    v_mul_u32_u24 v156, 1296, v1
    v_mad_u32_u24 v156, v5, s97, v156
    v_lshrrev_b32 v5, 1, v5
    v_mul_u32_u24 v5, 1440, v5
    v_add3_u32 v156, v156, v5, s61
    v_lshrrev_b32 v2, 3, v0
    v_lshl_add_u32 v156, v2, 4, v156
    v_lshrrev_b32 v157, 2, v2
    v_and_b32 v5, 3, v2
    v_lshlrev_b32 v157, 10, v157
    v_lshl_add_u32 v157, v5, 8, v157
    v_lshl_add_u32 v157, v1, 4, v157
    v_and_b32 v1, 15, v0
    v_lshrrev_b32 v2, 2, v1
    v_sub_u32 v3, 7, v2
    v_sub_u32 v2, 3, v2
    v_mul_u32_u24 v5, 11, v2
    v_lshrrev_b32 v5, 5, v5
    v_mul_u32_u24 v158, 1296, v2
    v_mad_u32_u24 v158, v5, s97, v158
    v_lshrrev_b32 v5, 1, v5
    v_mul_u32_u24 v5, 1440, v5
    v_add3_u32 v158, v158, v5, s61
    v_mul_u32_u24 v5, 11, v3
    v_lshrrev_b32 v5, 5, v5
    v_mul_u32_u24 v99, 1296, v3
    v_mad_u32_u24 v99, v5, s97, v99
    v_lshrrev_b32 v5, 1, v5
    v_mul_u32_u24 v5, 1440, v5
    v_add3_u32 v99, v99, v5, s61
    v_and_b32 v1, 3, v0
    v_lshrrev_b32 v2, 4, v0
    v_lshlrev_b32 v1, 3, v1
    v_lshl_add_u32 v1, v2, 5, v1
    v_add_u32 v158, v158, v1
    v_add_u32 v99, v99, v1
    v_lshlrev_b32 v159, 4, v0
    s_lshr_b32 s85, s93, 1
    s_mul_i32 s85, s85, 20480
    s_and_b32 s62, s93, 1
    s_lshl_b32 s62, s62, 7
    s_add_u32 s85, s85, s62
    s_lshl_b32 s62, s84, 11
    s_add_u32 s85, s85, s62
    s_add_u32 s86, s85, 8192
    s_add_u32 s87, s85, 16384
    s_mul_i32 s88, s93, 10240
    s_lshl_b32 s62, s84, 10
    s_add_u32 s88, s88, s62
    s_add_u32 s88, s88, 2621440
    s_add_u32 s89, s88, 4096
    s_add_u32 s90, s88, 6144
    s_waitcnt vmcnt(9)
    v_lshlrev_b32 v110, 16, v100
    v_and_b32 v111, 0xffff0000, v100
    v_lshlrev_b32 v112, 16, v101
    v_and_b32 v113, 0xffff0000, v101
    v_lshlrev_b32 v114, 16, v102
    v_and_b32 v115, 0xffff0000, v102
    v_lshlrev_b32 v116, 16, v103
    v_and_b32 v117, 0xffff0000, v103
    v_lshlrev_b32 v118, 16, v104
    v_and_b32 v119, 0xffff0000, v104
    v_lshlrev_b32 v120, 16, v105
    v_and_b32 v121, 0xffff0000, v105
    v_lshlrev_b32 v122, 16, v106
    v_and_b32 v123, 0xffff0000, v106
    v_lshlrev_b32 v124, 16, v107
    v_and_b32 v125, 0xffff0000, v107
    v_lshlrev_b32 v126, 16, v108
    v_and_b32 v127, 0xffff0000, v108
    v_lshlrev_b32 v128, 16, v109
    v_and_b32 v129, 0xffff0000, v109
    v_pk_add_f32 v[150:151], v[110:111], v[112:113]
    v_pk_add_f32 v[152:153], v[114:115], v[116:117]
    v_pk_add_f32 v[150:151], v[150:151], v[118:119]
    v_pk_add_f32 v[152:153], v[152:153], v[120:121]
    v_pk_add_f32 v[150:151], v[150:151], v[122:123]
    v_pk_add_f32 v[152:153], v[152:153], v[124:125]
    v_pk_add_f32 v[150:151], v[150:151], v[126:127]
    v_pk_add_f32 v[152:153], v[152:153], v[128:129]
    v_pk_add_f32 v[150:151], v[150:151], v[152:153]
    v_add_f32 v150, v150, v151
    s_nop 1
    v_add_f32_dpp v150, v150, v150 quad_perm:[1,0,3,2] row_mask:0xf bank_mask:0xf
    s_nop 1
    v_add_f32_dpp v150, v150, v150 quad_perm:[2,3,0,1] row_mask:0xf bank_mask:0xf
    s_nop 1
    v_add_f32_dpp v150, v150, v150 row_half_mirror row_mask:0xf bank_mask:0xf
    s_nop 1
    v_add_f32_dpp v150, v150, v150 row_mirror row_mask:0xf bank_mask:0xf
    v_mov_b32 v151, v150
    s_nop 1
    v_permlane16_swap_b32 v150, v151
    v_add_f32 v150, v150, v151
    v_mul_f32 v154, 0x3acccccd, v150
    v_pk_add_f32 v[130:131], v[110:111], v[154:155] op_sel_hi:[1,0] neg_lo:[0,1] neg_hi:[0,1]
    v_pk_add_f32 v[132:133], v[112:113], v[154:155] op_sel_hi:[1,0] neg_lo:[0,1] neg_hi:[0,1]
    v_pk_add_f32 v[134:135], v[114:115], v[154:155] op_sel_hi:[1,0] neg_lo:[0,1] neg_hi:[0,1]
    v_pk_add_f32 v[136:137], v[116:117], v[154:155] op_sel_hi:[1,0] neg_lo:[0,1] neg_hi:[0,1]
    v_pk_add_f32 v[138:139], v[118:119], v[154:155] op_sel_hi:[1,0] neg_lo:[0,1] neg_hi:[0,1]
    v_pk_add_f32 v[140:141], v[120:121], v[154:155] op_sel_hi:[1,0] neg_lo:[0,1] neg_hi:[0,1]
    v_pk_add_f32 v[142:143], v[122:123], v[154:155] op_sel_hi:[1,0] neg_lo:[0,1] neg_hi:[0,1]
    v_pk_add_f32 v[144:145], v[124:125], v[154:155] op_sel_hi:[1,0] neg_lo:[0,1] neg_hi:[0,1]
    v_pk_add_f32 v[146:147], v[126:127], v[154:155] op_sel_hi:[1,0] neg_lo:[0,1] neg_hi:[0,1]
    v_pk_add_f32 v[148:149], v[128:129], v[154:155] op_sel_hi:[1,0] neg_lo:[0,1] neg_hi:[0,1]
    v_pk_mul_f32 v[150:151], v[130:131], v[130:131]
    v_pk_mul_f32 v[152:153], v[132:133], v[132:133]
    v_pk_fma_f32 v[150:151], v[134:135], v[134:135], v[150:151]
    v_pk_fma_f32 v[152:153], v[136:137], v[136:137], v[152:153]
    v_pk_fma_f32 v[150:151], v[138:139], v[138:139], v[150:151]
    v_pk_fma_f32 v[152:153], v[140:141], v[140:141], v[152:153]
    v_pk_fma_f32 v[150:151], v[142:143], v[142:143], v[150:151]
    v_pk_fma_f32 v[152:153], v[144:145], v[144:145], v[152:153]
    v_pk_fma_f32 v[150:151], v[146:147], v[146:147], v[150:151]
    v_pk_fma_f32 v[152:153], v[148:149], v[148:149], v[152:153]
    v_pk_add_f32 v[150:151], v[150:151], v[152:153]
    v_add_f32 v150, v150, v151
    s_nop 1
    v_add_f32_dpp v150, v150, v150 quad_perm:[1,0,3,2] row_mask:0xf bank_mask:0xf
    s_nop 1
    v_add_f32_dpp v150, v150, v150 quad_perm:[2,3,0,1] row_mask:0xf bank_mask:0xf
    s_nop 1
    v_add_f32_dpp v150, v150, v150 row_half_mirror row_mask:0xf bank_mask:0xf
    s_nop 1
    v_add_f32_dpp v150, v150, v150 row_mirror row_mask:0xf bank_mask:0xf
    v_mov_b32 v151, v150
    s_nop 1
    v_permlane16_swap_b32 v150, v151
    v_add_f32 v150, v150, v151
    v_mul_f32 v155, 0x3acccccd, v150
    v_cvt_pk_bf16_f32 v150, v154, v155
    v_lshlrev_b32 v154, 16, v150
    v_and_b32 v152, 0xffff0000, v150
    v_add_f32 v152, 0x3727c5ac, v152
    v_cvt_pk_bf16_f32 v152, v152, v152
    v_and_b32 v152, 0xffff0000, v152
    v_sqrt_f32 v152, v152
    v_pk_add_f32 v[130:131], v[110:111], v[154:155] op_sel_hi:[1,0] neg_lo:[0,1] neg_hi:[0,1]
    v_pk_add_f32 v[132:133], v[112:113], v[154:155] op_sel_hi:[1,0] neg_lo:[0,1] neg_hi:[0,1]
    v_cvt_pk_bf16_f32 v152, v152, v152
    v_and_b32 v152, 0xffff0000, v152
    v_rcp_f32 v152, v152
    v_pk_add_f32 v[134:135], v[114:115], v[154:155] op_sel_hi:[1,0] neg_lo:[0,1] neg_hi:[0,1]
    v_pk_add_f32 v[136:137], v[116:117], v[154:155] op_sel_hi:[1,0] neg_lo:[0,1] neg_hi:[0,1]
    v_pk_add_f32 v[138:139], v[118:119], v[154:155] op_sel_hi:[1,0] neg_lo:[0,1] neg_hi:[0,1]
    v_pk_add_f32 v[140:141], v[120:121], v[154:155] op_sel_hi:[1,0] neg_lo:[0,1] neg_hi:[0,1]
    v_pk_add_f32 v[142:143], v[122:123], v[154:155] op_sel_hi:[1,0] neg_lo:[0,1] neg_hi:[0,1]
    v_pk_add_f32 v[144:145], v[124:125], v[154:155] op_sel_hi:[1,0] neg_lo:[0,1] neg_hi:[0,1]
    v_pk_add_f32 v[146:147], v[126:127], v[154:155] op_sel_hi:[1,0] neg_lo:[0,1] neg_hi:[0,1]
    v_pk_add_f32 v[148:149], v[128:129], v[154:155] op_sel_hi:[1,0] neg_lo:[0,1] neg_hi:[0,1]
    v_cvt_pk_bf16_f32 v100, v130, v131
    v_cvt_pk_bf16_f32 v101, v132, v133
    v_cvt_pk_bf16_f32 v102, v134, v135
    v_cvt_pk_bf16_f32 v103, v136, v137
    v_cvt_pk_bf16_f32 v104, v138, v139
    v_cvt_pk_bf16_f32 v105, v140, v141
    v_cvt_pk_bf16_f32 v106, v142, v143
    v_cvt_pk_bf16_f32 v107, v144, v145
    v_cvt_pk_bf16_f32 v108, v146, v147
    v_cvt_pk_bf16_f32 v109, v148, v149
    v_lshlrev_b32 v110, 16, v100
    v_and_b32 v111, 0xffff0000, v100
    v_lshlrev_b32 v112, 16, v101
    v_and_b32 v113, 0xffff0000, v101
    v_lshlrev_b32 v114, 16, v102
    v_and_b32 v115, 0xffff0000, v102
    v_lshlrev_b32 v116, 16, v103
    v_and_b32 v117, 0xffff0000, v103
    v_lshlrev_b32 v118, 16, v104
    v_and_b32 v119, 0xffff0000, v104
    v_lshlrev_b32 v120, 16, v105
    v_and_b32 v121, 0xffff0000, v105
    v_lshlrev_b32 v122, 16, v106
    v_and_b32 v123, 0xffff0000, v106
    v_lshlrev_b32 v124, 16, v107
    v_and_b32 v125, 0xffff0000, v107
    v_lshlrev_b32 v126, 16, v108
    v_and_b32 v127, 0xffff0000, v108
    v_lshlrev_b32 v128, 16, v109
    v_and_b32 v129, 0xffff0000, v109
    v_pk_mul_f32 v[110:111], v[110:111], v[152:153] op_sel_hi:[1,0]
    v_pk_mul_f32 v[112:113], v[112:113], v[152:153] op_sel_hi:[1,0]
    v_pk_mul_f32 v[114:115], v[114:115], v[152:153] op_sel_hi:[1,0]
    v_pk_mul_f32 v[116:117], v[116:117], v[152:153] op_sel_hi:[1,0]
    v_pk_mul_f32 v[118:119], v[118:119], v[152:153] op_sel_hi:[1,0]
    v_pk_mul_f32 v[120:121], v[120:121], v[152:153] op_sel_hi:[1,0]
    v_pk_mul_f32 v[122:123], v[122:123], v[152:153] op_sel_hi:[1,0]
    v_pk_mul_f32 v[124:125], v[124:125], v[152:153] op_sel_hi:[1,0]
    v_pk_mul_f32 v[126:127], v[126:127], v[152:153] op_sel_hi:[1,0]
    v_pk_mul_f32 v[128:129], v[128:129], v[152:153] op_sel_hi:[1,0]
    v_cvt_pk_bf16_f32 v100, v110, v111
    v_cvt_pk_bf16_f32 v101, v112, v113
    ds_write_b64 v98, v[100:101] offset:0
    v_cvt_pk_bf16_f32 v102, v114, v115
    v_cvt_pk_bf16_f32 v103, v116, v117
    ds_write_b64 v98, v[102:103] offset:256
    v_cvt_pk_bf16_f32 v104, v118, v119
    v_cvt_pk_bf16_f32 v105, v120, v121
    ds_write_b64 v98, v[104:105] offset:512
    v_cvt_pk_bf16_f32 v106, v122, v123
    v_cvt_pk_bf16_f32 v107, v124, v125
    ds_write_b64 v98, v[106:107] offset:768
    v_cvt_pk_bf16_f32 v108, v126, v127
    v_cvt_pk_bf16_f32 v109, v128, v129
    ds_write_b64 v98, v[108:109] offset:1024
    s_waitcnt lgkmcnt(0)
    s_lshl_b32 s60, s34, 2
    s_add_u32 s60, s60, 161808
    v_mov_b32 v2, s60
    v_mov_b32 v3, 1
    ds_write_b32 v2, v3
    v_mov_b32 v2, 161808
    s_mov_b32 s61, 0
fused_lnw4:
    ds_read_b128 v[4:7], v2
    s_add_u32 s61, s61, 1
    s_waitcnt lgkmcnt(0)
    v_min_u32 v4, v4, v5
    v_min_u32 v4, v4, v6
    v_min_u32 v4, v4, v7
    s_nop 0
    v_readfirstlane_b32 s60, v4
    s_cmp_gt_u32 s61, 0x200000
    s_cbranch_scc1 fused_lnw4_d
    s_cmp_lg_u32 s60, 0
    s_cbranch_scc1 fused_lnw4_d
    s_branch fused_lnw4
fused_lnw4_d:
    v_mov_b32 v97, 0
    v_mov_b32 v96, 0
    s_cmp_lg_u32 s34, 0
    s_cbranch_scc1 fused_g_n0
    global_load_dword v96, v97, s[30:31] sc1
fused_g_n0:
    ds_read_b128 v[160:163], v156
    ds_read_b128 v[164:167], v156 offset:512
    ds_read_b128 v[168:171], v156 offset:1024
    ds_read_b64_tr_b16 v[172:173], v99
    ds_read_b64_tr_b16 v[174:175], v158
    ds_read_b64_tr_b16 v[176:177], v99 offset:512
    ds_read_b64_tr_b16 v[178:179], v158 offset:512
    ds_read_b64_tr_b16 v[180:181], v99 offset:768
    ds_read_b64_tr_b16 v[182:183], v158 offset:768
    s_cmp_ge_u32 s84, 2
    s_waitcnt lgkmcnt(7)
    buffer_store_dwordx4 v[160:163], v157, s[44:47], s85 offen sc1
    s_waitcnt lgkmcnt(6)
    buffer_store_dwordx4 v[164:167], v157, s[44:47], s86 offen sc1
    s_cselect_b32 s87, 17825792, s87
    s_waitcnt lgkmcnt(5)
    buffer_store_dwordx4 v[168:171], v157, s[44:47], s87 offen sc1
    s_waitcnt vmcnt(3)
    v_mov_b32 v2, 161580
    v_mov_b32 v3, 1
    s_mov_b64 exec, 1
    ds_add_u32 v2, v3
    s_mov_b64 exec, -1
    v_lshlrev_b32 v16, 16, v64
    v_and_b32 v17, 0xffff0000, v64
    v_lshlrev_b32 v18, 16, v65
    v_and_b32 v19, 0xffff0000, v65
    v_lshlrev_b32 v20, 16, v64
    v_and_b32 v21, 0xffff0000, v64
    v_lshlrev_b32 v22, 16, v65
    v_and_b32 v23, 0xffff0000, v65
    v_lshlrev_b32 v24, 16, v66
    v_and_b32 v25, 0xffff0000, v66
    v_lshlrev_b32 v26, 16, v67
    v_and_b32 v27, 0xffff0000, v67
    v_lshlrev_b32 v28, 16, v66
    v_and_b32 v29, 0xffff0000, v66
    v_lshlrev_b32 v30, 16, v67
    v_and_b32 v31, 0xffff0000, v67
    v_lshlrev_b32 v32, 16, v68
    v_and_b32 v33, 0xffff0000, v68
    v_lshlrev_b32 v34, 16, v69
    v_and_b32 v35, 0xffff0000, v69
    v_lshlrev_b32 v36, 16, v68
    v_and_b32 v37, 0xffff0000, v68
    v_lshlrev_b32 v38, 16, v69
    v_and_b32 v39, 0xffff0000, v69
    v_lshlrev_b32 v40, 16, v70
    v_and_b32 v41, 0xffff0000, v70
    v_lshlrev_b32 v42, 16, v71
    v_and_b32 v43, 0xffff0000, v71
    v_lshlrev_b32 v44, 16, v70
    v_and_b32 v45, 0xffff0000, v70
    v_lshlrev_b32 v46, 16, v71
    v_and_b32 v47, 0xffff0000, v71
    v_lshlrev_b32 v48, 16, v72
    v_and_b32 v49, 0xffff0000, v72
    v_lshlrev_b32 v50, 16, v73
    v_and_b32 v51, 0xffff0000, v73
    v_lshlrev_b32 v52, 16, v72
    v_and_b32 v53, 0xffff0000, v72
    v_lshlrev_b32 v54, 16, v73
    v_and_b32 v55, 0xffff0000, v73
    v_lshlrev_b32 v56, 16, v74
    v_and_b32 v57, 0xffff0000, v74
    v_lshlrev_b32 v58, 16, v75
    v_and_b32 v59, 0xffff0000, v75
    v_lshlrev_b32 v60, 16, v74
    v_and_b32 v61, 0xffff0000, v74
    v_lshlrev_b32 v62, 16, v75
    v_and_b32 v63, 0xffff0000, v75
    v_lshrrev_b32 v5, 4, v0
    v_and_b32 v6, 15, v0
    v_lshrrev_b32 v6, 2, v6
    v_lshl_add_u32 v6, v5, 3, v6
    v_mul_u32_u24 v6, 192, v6
    v_and_b32 v7, 3, v0
    v_lshl_add_u32 v6, v7, 3, v6
    v_and_b32 v5, 1, v5
    v_lshlrev_b32 v5, 5, v5
    v_add_u32 v10, v6, v5
    v_sub_u32 v11, v6, v5
    v_add_u32 v12, 61440, v10
    v_add_u32 v13, 61440, v11
    s_lshl_b32 s86, s37, 3
    s_lshl_b32 s87, s34, 1
    s_add_u32 s86, s86, s87
    s_mul_i32 s82, s86, 20480
    s_add_u32 s83, s82, 20480
    s_mul_i32 s86, s86, 49152
    s_mul_i32 s87, s38, 3072
    s_add_u32 s86, s86, s87
    s_add_u32 s86, s86, 5242880
    s_add_u32 s87, s86, 49152
    v_lshlrev_b32 v9, 4, v0
    v_add_u32 v8, 4096, v9
    s_mul_i32 s74, s40, 245760
    s_mul_i32 s60, s34, 61440
    s_add_u32 s74, s74, s60
    s_add_u32 s74, s74, 11534336
    s_mul_i32 s75, s34, 30720
    s_waitcnt vmcnt(0)
    s_cmp_eq_u32 s34, 0
    s_cbranch_scc1 fused_g_w0
    v_mov_b32 v2, 161568
    v_mov_b32 v3, 1
    s_mov_b64 exec, 1
    ds_add_u32 v2, v3
    s_mov_b64 exec, -1
    s_branch fused_g_j
fused_g_w0:
    s_mov_b32 s64, 0
fused_np:
    v_readfirstlane_b32 s96, v96
    s_cmp_gt_u32 s64, 0x20000
    s_cbranch_scc1 fused_npd
    s_cmp_lg_u32 s96, 0
    s_cbranch_scc1 fused_npd
    global_load_dword v96, v97, s[30:31] sc1
    s_add_u32 s64, s64, 1
    s_waitcnt vmcnt(0)
    s_nop 1
    s_branch fused_np
fused_npd:
    v_mov_b32 v2, s96
    v_mov_b32 v3, 161680
    ds_write_b32 v3, v2
    v_mov_b32 v3, 161568
    s_mov_b32 s64, 0
fused_lc:
    ds_read_b32 v2, v3
    s_add_u32 s64, s64, 1
    s_waitcnt lgkmcnt(0)
    v_readfirstlane_b32 s60, v2
    s_cmp_gt_u32 s64, 0x200000
    s_cbranch_scc1 fused_lcd
    s_cmp_lt_u32 s60, 3
    s_cbranch_scc1 fused_lc
fused_lcd:
    s_mul_i32 s66, s93, 128
    s_add_u32 s66, s66, 16252928
    v_mov_b32 v2, s96
    s_mov_b64 s[62:63], exec
    s_mov_b64 exec, 1
    buffer_store_dword v2, off, s[44:47], s66 sc1
    s_mov_b64 exec, s[62:63]
fused_g_j:
    s_cmp_lt_u32 s84, 2
    s_waitcnt lgkmcnt(0)
    buffer_store_dwordx4 v[172:175], v159, s[44:47], s88 offen sc1
    buffer_store_dwordx4 v[176:179], v159, s[44:47], s89 offen sc1
    s_cselect_b32 s90, 17825792, s90
    buffer_store_dwordx4 v[180:183], v159, s[44:47], s90 offen sc1
    v_mov_b32 v2, 161576
    v_mov_b32 v3, 1
    s_mov_b64 exec, 1
    ds_add_u32 v2, v3
    s_mov_b64 exec, -1
    v_mov_b32 v2, 161680
    s_mov_b32 s61, 0
fused_gn:
    ds_read_b128 v[4:7], v2
    s_add_u32 s61, s61, 1
    s_waitcnt lgkmcnt(0)
    v_readfirstlane_b32 s60, v4
    s_cmp_gt_u32 s61, 0x200000
    s_cbranch_scc1 fused_gn_d
    s_cmp_lg_u32 s60, 0
    s_cbranch_scc1 fused_gn_d
    s_sleep 1
    s_branch fused_gn
fused_gn_d:
    s_mov_b32 s96, s60
    s_lshl_b32 s66, s37, 2
    s_add_u32 s66, s66, s34
    s_mul_i32 s66, s66, 512
    s_add_u32 s66, s66, 16252928
    s_mov_b32 s71, 0
    s_add_u32 s62, s32, s66
    s_addc_u32 s63, s33, 0
    s_mov_b32 s64, 0
fused_pln:
    s_load_dword s4, s[62:63], 0 glc
    s_load_dword s5, s[62:63], 128 glc
    s_load_dword s6, s[62:63], 256 glc
    s_load_dword s7, s[62:63], 384 glc
    s_add_u32 s64, s64, 1
    s_waitcnt lgkmcnt(0)
    s_xor_b32 s4, s4, s96
    s_xor_b32 s5, s5, s96
    s_xor_b32 s6, s6, s96
    s_xor_b32 s7, s7, s96
    s_or_b32 s4, s4, s5
    s_or_b32 s6, s6, s7
    s_or_b32 s4, s4, s6
    s_cmp_eq_u32 s4, 0
    s_cbranch_scc1 fused_pln_d
    s_cmp_lg_u32 s71, 0
    s_cbranch_scc1 fused_flta
    s_mov_b32 s71, 1
    s_waitcnt vmcnt(0)
    v_mov_b32 v2, 161716
    v_mov_b32 v3, 1
    s_mov_b64 exec, 1
    ds_add_rtn_u32 v4, v2, v3
    s_mov_b64 exec, -1
    s_mul_i32 s65, s93, 128
    s_add_u32 s65, s65, 16547840
    s_waitcnt lgkmcnt(0)
    s_nop 1
    v_readfirstlane_b32 s60, v4
    s_nop 1
    s_cmp_lg_u32 s60, 3
    s_cbranch_scc1 fused_flta
    v_mov_b32 v2, s96
    s_mov_b64 exec, 1
    buffer_store_dword v2, off, s[44:47], s65 sc1
    s_mov_b64 exec, -1
fused_flta:
    s_sleep 1
    s_cmp_lt_u32 s64, 0x20000
    s_cbranch_scc1 fused_pln
fused_pln_d:
    buffer_load_dwordx4 v[96:99], v9, s[44:47], s82 offen offset:0 sc1
    buffer_load_dwordx4 v[100:103], v9, s[44:47], s83 offen offset:0 sc1
    buffer_load_dwordx4 v[104:107], v9, s[44:47], s82 offen offset:1024 sc1
    buffer_load_dwordx4 v[108:111], v9, s[44:47], s83 offen offset:1024 sc1
    s_cmp_lg_u32 s71, 0
    s_cbranch_scc1 fused_fltb
    s_mov_b32 s71, 1
    s_waitcnt vmcnt(4)
    v_mov_b32 v2, 161716
    v_mov_b32 v3, 1
    s_mov_b64 exec, 1
    ds_add_rtn_u32 v4, v2, v3
    s_mov_b64 exec, -1
    s_mul_i32 s65, s93, 128
    s_add_u32 s65, s65, 16547840
    s_waitcnt lgkmcnt(0)
    s_nop 1
    v_readfirstlane_b32 s60, v4
    s_nop 1
    s_cmp_lg_u32 s60, 3
    s_cbranch_scc1 fused_fltb
    v_mov_b32 v2, s96
    s_mov_b64 exec, 1
    buffer_store_dword v2, off, s[44:47], s65 sc1
    s_mov_b64 exec, -1
fused_fltb:
    buffer_load_dwordx4 v[112:115], v9, s[44:47], s82 offen offset:2048 sc1
    buffer_load_dwordx4 v[116:119], v9, s[44:47], s83 offen offset:2048 sc1
    buffer_load_dwordx4 v[120:123], v9, s[44:47], s82 offen offset:3072 sc1
    s_add_u32 s82, s82, 4096
    buffer_load_dwordx4 v[124:127], v9, s[44:47], s83 offen offset:3072 sc1
    s_add_u32 s83, s83, 4096
    buffer_load_dwordx4 v[128:131], v9, s[44:47], s82 offen offset:0 sc1
    buffer_load_dwordx4 v[132:135], v9, s[44:47], s83 offen offset:0 sc1
    s_cmp_lt_u32 s41, 3
    s_cselect_b32 s65, 6, 5
    v_mov_b32 v2, 161580
    s_mov_b32 s61, 0
fused_w1w:
    ds_read_b32 v3, v2
    s_add_u32 s61, s61, 1
    s_waitcnt lgkmcnt(0)
    v_readfirstlane_b32 s60, v3
    s_cmp_gt_u32 s61, 0x200000
    s_cbranch_scc1 fused_w1w_d
    s_cmp_ge_u32 s60, s65
    s_cbranch_scc1 fused_w1w_d
    s_branch fused_w1w
fused_w1w_d:
    s_add_u32 s60, s34, 0
    s_and_b32 s60, s60, 3
    s_lshl_b32 s61, s39, 2
    s_add_u32 s60, s60, s61
    s_mul_i32 s60, s60, 49152
    s_mul_i32 s61, s34, 12288
    s_add_u32 s60, s60, s61
    s_add_u32 s76, s60, 5242880
    s_add_u32 s60, s34, 1
    s_and_b32 s60, s60, 3
    s_lshl_b32 s61, s39, 2
    s_add_u32 s60, s60, s61
    s_mul_i32 s60, s60, 49152
    s_mul_i32 s61, s34, 12288
    s_add_u32 s60, s60, s61
    s_add_u32 s77, s60, 5242880
    s_add_u32 s60, s34, 2
    s_and_b32 s60, s60, 3
    s_lshl_b32 s61, s39, 2
    s_add_u32 s60, s60, s61
    s_mul_i32 s60, s60, 49152
    s_mul_i32 s61, s34, 12288
    s_add_u32 s60, s60, s61
    s_add_u32 s78, s60, 5242880
    s_add_u32 s60, s34, 3
    s_and_b32 s60, s60, 3
    s_lshl_b32 s61, s39, 2
    s_add_u32 s60, s60, s61
    s_mul_i32 s60, s60, 49152
    s_mul_i32 s61, s34, 12288
    s_add_u32 s60, s60, s61
    s_add_u32 s79, s60, 5242880
    ds_read_b64_tr_b16 v[64:65], v10 offset:0
    ds_read_b64_tr_b16 v[66:67], v10 offset:768
    ds_read_b64_tr_b16 v[68:69], v11 offset:32
    ds_read_b64_tr_b16 v[70:71], v11 offset:800
    ds_read_b64_tr_b16 v[72:73], v10 offset:64
    ds_read_b64_tr_b16 v[74:75], v10 offset:832
    ds_read_b64_tr_b16 v[76:77], v11 offset:96
    ds_read_b64_tr_b16 v[78:79], v11 offset:864
    ds_read_b64_tr_b16 v[80:81], v10 offset:128
    ds_read_b64_tr_b16 v[82:83], v10 offset:896
    ds_read_b64_tr_b16 v[84:85], v11 offset:160
    ds_read_b64_tr_b16 v[86:87], v11 offset:928
    ds_read_b64_tr_b16 v[88:89], v10 offset:6144
    ds_read_b64_tr_b16 v[90:91], v10 offset:6912
    s_waitcnt vmcnt(8)
    s_waitcnt lgkmcnt(10)
    v_mfma_f32_16x16x32_bf16 v[16:19], v[64:67], v[96:99], v[16:19]
    ds_read_b64_tr_b16 v[92:93], v11 offset:6176
    v_mfma_f32_16x16x32_bf16 v[20:23], v[64:67], v[100:103], v[20:23]
    ds_read_b64_tr_b16 v[94:95], v11 offset:6944
    buffer_load_dwordx4 v[136:139], v9, s[44:47], s82 offen offset:1024 sc1
    v_mfma_f32_16x16x32_bf16 v[24:27], v[68:71], v[96:99], v[24:27]
    ds_read_b64_tr_b16 v[64:65], v10 offset:6208
    v_mfma_f32_16x16x32_bf16 v[28:31], v[68:71], v[100:103], v[28:31]
    ds_read_b64_tr_b16 v[66:67], v10 offset:6976
    s_waitcnt lgkmcnt(10)
    v_mfma_f32_16x16x32_bf16 v[32:35], v[72:75], v[96:99], v[32:35]
    ds_read_b64_tr_b16 v[68:69], v11 offset:6240
    v_mfma_f32_16x16x32_bf16 v[36:39], v[72:75], v[100:103], v[36:39]
    ds_read_b64_tr_b16 v[70:71], v11 offset:7008
    buffer_load_dwordx4 v[140:143], v9, s[44:47], s83 offen offset:1024 sc1
    v_mfma_f32_16x16x32_bf16 v[40:43], v[76:79], v[96:99], v[40:43]
    ds_read_b64_tr_b16 v[72:73], v10 offset:6272
    v_mfma_f32_16x16x32_bf16 v[44:47], v[76:79], v[100:103], v[44:47]
    ds_read_b64_tr_b16 v[74:75], v10 offset:7040
    s_waitcnt lgkmcnt(10)
    v_mfma_f32_16x16x32_bf16 v[48:51], v[80:83], v[96:99], v[48:51]
    ds_read_b64_tr_b16 v[76:77], v11 offset:6304
    v_mfma_f32_16x16x32_bf16 v[52:55], v[80:83], v[100:103], v[52:55]
    ds_read_b64_tr_b16 v[78:79], v11 offset:7072
    v_mfma_f32_16x16x32_bf16 v[56:59], v[84:87], v[96:99], v[56:59]
    ds_read_b64_tr_b16 v[80:81], v10 offset:12288
    v_mfma_f32_16x16x32_bf16 v[60:63], v[84:87], v[100:103], v[60:63]
    ds_read_b64_tr_b16 v[82:83], v10 offset:13056
    s_waitcnt vmcnt(8)
    s_waitcnt lgkmcnt(10)
    v_mfma_f32_16x16x32_bf16 v[16:19], v[88:91], v[104:107], v[16:19]
    ds_read_b64_tr_b16 v[84:85], v11 offset:12320
    v_mfma_f32_16x16x32_bf16 v[20:23], v[88:91], v[108:111], v[20:23]
    ds_read_b64_tr_b16 v[86:87], v11 offset:13088
    buffer_load_dwordx4 v[144:147], v9, s[44:47], s82 offen offset:2048 sc1
    v_mfma_f32_16x16x32_bf16 v[24:27], v[92:95], v[104:107], v[24:27]
    ds_read_b64_tr_b16 v[88:89], v10 offset:12352
    v_mfma_f32_16x16x32_bf16 v[28:31], v[92:95], v[108:111], v[28:31]
    ds_read_b64_tr_b16 v[90:91], v10 offset:13120
    s_waitcnt lgkmcnt(10)
    v_mfma_f32_16x16x32_bf16 v[32:35], v[64:67], v[104:107], v[32:35]
    ds_read_b64_tr_b16 v[92:93], v11 offset:12384
    v_mfma_f32_16x16x32_bf16 v[36:39], v[64:67], v[108:111], v[36:39]
    ds_read_b64_tr_b16 v[94:95], v11 offset:13152
    buffer_load_dwordx4 v[148:151], v9, s[44:47], s83 offen offset:2048 sc1
    v_mfma_f32_16x16x32_bf16 v[40:43], v[68:71], v[104:107], v[40:43]
    ds_read_b64_tr_b16 v[64:65], v10 offset:12416
    v_mfma_f32_16x16x32_bf16 v[44:47], v[68:71], v[108:111], v[44:47]
    ds_read_b64_tr_b16 v[66:67], v10 offset:13184
    s_waitcnt lgkmcnt(10)
    v_mfma_f32_16x16x32_bf16 v[48:51], v[72:75], v[104:107], v[48:51]
    ds_read_b64_tr_b16 v[68:69], v11 offset:12448
    v_mfma_f32_16x16x32_bf16 v[52:55], v[72:75], v[108:111], v[52:55]
    ds_read_b64_tr_b16 v[70:71], v11 offset:13216
    v_mfma_f32_16x16x32_bf16 v[56:59], v[76:79], v[104:107], v[56:59]
    ds_read_b64_tr_b16 v[72:73], v10 offset:18432
    v_mfma_f32_16x16x32_bf16 v[60:63], v[76:79], v[108:111], v[60:63]
    ds_read_b64_tr_b16 v[74:75], v10 offset:19200
    s_waitcnt vmcnt(8)
    s_waitcnt lgkmcnt(10)
    v_mfma_f32_16x16x32_bf16 v[16:19], v[80:83], v[112:115], v[16:19]
    ds_read_b64_tr_b16 v[76:77], v11 offset:18464
    v_mfma_f32_16x16x32_bf16 v[20:23], v[80:83], v[116:119], v[20:23]
    ds_read_b64_tr_b16 v[78:79], v11 offset:19232
    buffer_load_dwordx4 v[152:155], v9, s[44:47], s82 offen offset:3072 sc1
    s_add_u32 s82, s82, 4096
    v_mfma_f32_16x16x32_bf16 v[24:27], v[84:87], v[112:115], v[24:27]
    ds_read_b64_tr_b16 v[80:81], v10 offset:18496
    v_mfma_f32_16x16x32_bf16 v[28:31], v[84:87], v[116:119], v[28:31]
    ds_read_b64_tr_b16 v[82:83], v10 offset:19264
    s_waitcnt lgkmcnt(10)
    v_mfma_f32_16x16x32_bf16 v[32:35], v[88:91], v[112:115], v[32:35]
    ds_read_b64_tr_b16 v[84:85], v11 offset:18528
    v_mfma_f32_16x16x32_bf16 v[36:39], v[88:91], v[116:119], v[36:39]
    ds_read_b64_tr_b16 v[86:87], v11 offset:19296
    buffer_load_dwordx4 v[156:159], v9, s[44:47], s83 offen offset:3072 sc1
    s_add_u32 s83, s83, 4096
    v_mfma_f32_16x16x32_bf16 v[40:43], v[92:95], v[112:115], v[40:43]
    ds_read_b64_tr_b16 v[88:89], v10 offset:18560
    v_mfma_f32_16x16x32_bf16 v[44:47], v[92:95], v[116:119], v[44:47]
    ds_read_b64_tr_b16 v[90:91], v10 offset:19328
    s_waitcnt lgkmcnt(10)
    v_mfma_f32_16x16x32_bf16 v[48:51], v[64:67], v[112:115], v[48:51]
    ds_read_b64_tr_b16 v[92:93], v11 offset:18592
    v_mfma_f32_16x16x32_bf16 v[52:55], v[64:67], v[116:119], v[52:55]
    ds_read_b64_tr_b16 v[94:95], v11 offset:19360
    v_mfma_f32_16x16x32_bf16 v[56:59], v[68:71], v[112:115], v[56:59]
    ds_read_b64_tr_b16 v[64:65], v10 offset:24576
    v_mfma_f32_16x16x32_bf16 v[60:63], v[68:71], v[116:119], v[60:63]
    ds_read_b64_tr_b16 v[66:67], v10 offset:25344
    s_waitcnt vmcnt(8)
    s_waitcnt lgkmcnt(10)
    v_mfma_f32_16x16x32_bf16 v[16:19], v[72:75], v[120:123], v[16:19]
    ds_read_b64_tr_b16 v[68:69], v11 offset:24608
    v_mfma_f32_16x16x32_bf16 v[20:23], v[72:75], v[124:127], v[20:23]
    ds_read_b64_tr_b16 v[70:71], v11 offset:25376
    buffer_load_dwordx4 v[160:163], v9, s[44:47], s82 offen offset:0 sc1
    v_mfma_f32_16x16x32_bf16 v[24:27], v[76:79], v[120:123], v[24:27]
    ds_read_b64_tr_b16 v[72:73], v10 offset:24640
    v_mfma_f32_16x16x32_bf16 v[28:31], v[76:79], v[124:127], v[28:31]
    ds_read_b64_tr_b16 v[74:75], v10 offset:25408
    s_waitcnt lgkmcnt(10)
    v_mfma_f32_16x16x32_bf16 v[32:35], v[80:83], v[120:123], v[32:35]
    ds_read_b64_tr_b16 v[76:77], v11 offset:24672
    v_mfma_f32_16x16x32_bf16 v[36:39], v[80:83], v[124:127], v[36:39]
    ds_read_b64_tr_b16 v[78:79], v11 offset:25440
    buffer_load_dwordx4 v[164:167], v9, s[44:47], s83 offen offset:0 sc1
    v_mfma_f32_16x16x32_bf16 v[40:43], v[84:87], v[120:123], v[40:43]
    ds_read_b64_tr_b16 v[80:81], v10 offset:24704
    v_mfma_f32_16x16x32_bf16 v[44:47], v[84:87], v[124:127], v[44:47]
    ds_read_b64_tr_b16 v[82:83], v10 offset:25472
    s_waitcnt lgkmcnt(10)
    v_mfma_f32_16x16x32_bf16 v[48:51], v[88:91], v[120:123], v[48:51]
    ds_read_b64_tr_b16 v[84:85], v11 offset:24736
    v_mfma_f32_16x16x32_bf16 v[52:55], v[88:91], v[124:127], v[52:55]
    ds_read_b64_tr_b16 v[86:87], v11 offset:25504
    v_mfma_f32_16x16x32_bf16 v[56:59], v[92:95], v[120:123], v[56:59]
    ds_read_b64_tr_b16 v[88:89], v10 offset:30720
    v_mfma_f32_16x16x32_bf16 v[60:63], v[92:95], v[124:127], v[60:63]
    ds_read_b64_tr_b16 v[90:91], v10 offset:31488
    s_waitcnt vmcnt(8)
    s_waitcnt lgkmcnt(10)
    v_mfma_f32_16x16x32_bf16 v[16:19], v[64:67], v[128:131], v[16:19]
    ds_read_b64_tr_b16 v[92:93], v11 offset:30752
    v_mfma_f32_16x16x32_bf16 v[20:23], v[64:67], v[132:135], v[20:23]
    ds_read_b64_tr_b16 v[94:95], v11 offset:31520
    buffer_load_dwordx4 v[168:171], v9, s[44:47], s82 offen offset:1024 sc1
    v_mfma_f32_16x16x32_bf16 v[24:27], v[68:71], v[128:131], v[24:27]
    ds_read_b64_tr_b16 v[64:65], v10 offset:30784
    v_mfma_f32_16x16x32_bf16 v[28:31], v[68:71], v[132:135], v[28:31]
    ds_read_b64_tr_b16 v[66:67], v10 offset:31552
    s_waitcnt lgkmcnt(10)
    v_mfma_f32_16x16x32_bf16 v[32:35], v[72:75], v[128:131], v[32:35]
    ds_read_b64_tr_b16 v[68:69], v11 offset:30816
    v_mfma_f32_16x16x32_bf16 v[36:39], v[72:75], v[132:135], v[36:39]
    ds_read_b64_tr_b16 v[70:71], v11 offset:31584
    buffer_load_dwordx4 v[172:175], v9, s[44:47], s83 offen offset:1024 sc1
    v_mfma_f32_16x16x32_bf16 v[40:43], v[76:79], v[128:131], v[40:43]
    ds_read_b64_tr_b16 v[72:73], v10 offset:30848
    v_mfma_f32_16x16x32_bf16 v[44:47], v[76:79], v[132:135], v[44:47]
    ds_read_b64_tr_b16 v[74:75], v10 offset:31616
    s_waitcnt lgkmcnt(10)
    v_mfma_f32_16x16x32_bf16 v[48:51], v[80:83], v[128:131], v[48:51]
    ds_read_b64_tr_b16 v[76:77], v11 offset:30880
    v_mfma_f32_16x16x32_bf16 v[52:55], v[80:83], v[132:135], v[52:55]
    ds_read_b64_tr_b16 v[78:79], v11 offset:31648
    v_mfma_f32_16x16x32_bf16 v[56:59], v[84:87], v[128:131], v[56:59]
    ds_read_b64_tr_b16 v[80:81], v10 offset:36864
    v_mfma_f32_16x16x32_bf16 v[60:63], v[84:87], v[132:135], v[60:63]
    ds_read_b64_tr_b16 v[82:83], v10 offset:37632
    s_waitcnt vmcnt(8)
    s_waitcnt lgkmcnt(10)
    v_mfma_f32_16x16x32_bf16 v[16:19], v[88:91], v[136:139], v[16:19]
    ds_read_b64_tr_b16 v[84:85], v11 offset:36896
    v_mfma_f32_16x16x32_bf16 v[20:23], v[88:91], v[140:143], v[20:23]
    ds_read_b64_tr_b16 v[86:87], v11 offset:37664
    buffer_load_dwordx4 v[176:179], v9, s[44:47], s82 offen offset:2048 sc1
    v_mfma_f32_16x16x32_bf16 v[24:27], v[92:95], v[136:139], v[24:27]
    ds_read_b64_tr_b16 v[88:89], v10 offset:36928
    v_mfma_f32_16x16x32_bf16 v[28:31], v[92:95], v[140:143], v[28:31]
    ds_read_b64_tr_b16 v[90:91], v10 offset:37696
    s_waitcnt lgkmcnt(10)
    v_mfma_f32_16x16x32_bf16 v[32:35], v[64:67], v[136:139], v[32:35]
    ds_read_b64_tr_b16 v[92:93], v11 offset:36960
    v_mfma_f32_16x16x32_bf16 v[36:39], v[64:67], v[140:143], v[36:39]
    ds_read_b64_tr_b16 v[94:95], v11 offset:37728
    buffer_load_dwordx4 v[180:183], v9, s[44:47], s83 offen offset:2048 sc1
    v_mfma_f32_16x16x32_bf16 v[40:43], v[68:71], v[136:139], v[40:43]
    ds_read_b64_tr_b16 v[64:65], v10 offset:36992
    v_mfma_f32_16x16x32_bf16 v[44:47], v[68:71], v[140:143], v[44:47]
    ds_read_b64_tr_b16 v[66:67], v10 offset:37760
    s_waitcnt lgkmcnt(10)
    v_mfma_f32_16x16x32_bf16 v[48:51], v[72:75], v[136:139], v[48:51]
    ds_read_b64_tr_b16 v[68:69], v11 offset:37024
    v_mfma_f32_16x16x32_bf16 v[52:55], v[72:75], v[140:143], v[52:55]
    ds_read_b64_tr_b16 v[70:71], v11 offset:37792
    v_mfma_f32_16x16x32_bf16 v[56:59], v[76:79], v[136:139], v[56:59]
    ds_read_b64_tr_b16 v[72:73], v10 offset:43008
    v_mfma_f32_16x16x32_bf16 v[60:63], v[76:79], v[140:143], v[60:63]
    ds_read_b64_tr_b16 v[74:75], v10 offset:43776
    s_waitcnt vmcnt(8)
    s_waitcnt lgkmcnt(10)
    v_mfma_f32_16x16x32_bf16 v[16:19], v[80:83], v[144:147], v[16:19]
    ds_read_b64_tr_b16 v[76:77], v11 offset:43040
    v_mfma_f32_16x16x32_bf16 v[20:23], v[80:83], v[148:151], v[20:23]
    ds_read_b64_tr_b16 v[78:79], v11 offset:43808
    buffer_load_dwordx4 v[184:187], v9, s[44:47], s82 offen offset:3072 sc1
    s_add_u32 s82, s82, 4096
    v_mfma_f32_16x16x32_bf16 v[24:27], v[84:87], v[144:147], v[24:27]
    ds_read_b64_tr_b16 v[80:81], v10 offset:43072
    v_mfma_f32_16x16x32_bf16 v[28:31], v[84:87], v[148:151], v[28:31]
    ds_read_b64_tr_b16 v[82:83], v10 offset:43840
    s_waitcnt lgkmcnt(10)
    v_mfma_f32_16x16x32_bf16 v[32:35], v[88:91], v[144:147], v[32:35]
    ds_read_b64_tr_b16 v[84:85], v11 offset:43104
    v_mfma_f32_16x16x32_bf16 v[36:39], v[88:91], v[148:151], v[36:39]
    ds_read_b64_tr_b16 v[86:87], v11 offset:43872
    buffer_load_dwordx4 v[188:191], v9, s[44:47], s83 offen offset:3072 sc1
    s_add_u32 s83, s83, 4096
    v_mfma_f32_16x16x32_bf16 v[40:43], v[92:95], v[144:147], v[40:43]
    ds_read_b64_tr_b16 v[88:89], v10 offset:43136
    v_mfma_f32_16x16x32_bf16 v[44:47], v[92:95], v[148:151], v[44:47]
    ds_read_b64_tr_b16 v[90:91], v10 offset:43904
    s_waitcnt lgkmcnt(10)
    v_mfma_f32_16x16x32_bf16 v[48:51], v[64:67], v[144:147], v[48:51]
    ds_read_b64_tr_b16 v[92:93], v11 offset:43168
    v_mfma_f32_16x16x32_bf16 v[52:55], v[64:67], v[148:151], v[52:55]
    ds_read_b64_tr_b16 v[94:95], v11 offset:43936
    v_mfma_f32_16x16x32_bf16 v[56:59], v[68:71], v[144:147], v[56:59]
    ds_read_b64_tr_b16 v[64:65], v10 offset:49152
    v_mfma_f32_16x16x32_bf16 v[60:63], v[68:71], v[148:151], v[60:63]
    ds_read_b64_tr_b16 v[66:67], v10 offset:49920
    s_waitcnt vmcnt(8)
    s_waitcnt lgkmcnt(10)
    v_mfma_f32_16x16x32_bf16 v[16:19], v[72:75], v[152:155], v[16:19]
    ds_read_b64_tr_b16 v[68:69], v11 offset:49184
    v_mfma_f32_16x16x32_bf16 v[20:23], v[72:75], v[156:159], v[20:23]
    ds_read_b64_tr_b16 v[70:71], v11 offset:49952
    buffer_load_dwordx4 v[192:195], v9, s[44:47], s82 offen offset:0 sc1
    v_mfma_f32_16x16x32_bf16 v[24:27], v[76:79], v[152:155], v[24:27]
    ds_read_b64_tr_b16 v[72:73], v10 offset:49216
    v_mfma_f32_16x16x32_bf16 v[28:31], v[76:79], v[156:159], v[28:31]
    ds_read_b64_tr_b16 v[74:75], v10 offset:49984
    s_waitcnt lgkmcnt(10)
    v_mfma_f32_16x16x32_bf16 v[32:35], v[80:83], v[152:155], v[32:35]
    ds_read_b64_tr_b16 v[76:77], v11 offset:49248
    v_mfma_f32_16x16x32_bf16 v[36:39], v[80:83], v[156:159], v[36:39]
    ds_read_b64_tr_b16 v[78:79], v11 offset:50016
    buffer_load_dwordx4 v[196:199], v9, s[44:47], s83 offen offset:0 sc1
    v_mfma_f32_16x16x32_bf16 v[40:43], v[84:87], v[152:155], v[40:43]
    ds_read_b64_tr_b16 v[80:81], v10 offset:49280
    v_mfma_f32_16x16x32_bf16 v[44:47], v[84:87], v[156:159], v[44:47]
    ds_read_b64_tr_b16 v[82:83], v10 offset:50048
    s_waitcnt lgkmcnt(10)
    v_mfma_f32_16x16x32_bf16 v[48:51], v[88:91], v[152:155], v[48:51]
    ds_read_b64_tr_b16 v[84:85], v11 offset:49312
    v_mfma_f32_16x16x32_bf16 v[52:55], v[88:91], v[156:159], v[52:55]
    ds_read_b64_tr_b16 v[86:87], v11 offset:50080
    v_mfma_f32_16x16x32_bf16 v[56:59], v[92:95], v[152:155], v[56:59]
    ds_read_b64_tr_b16 v[88:89], v10 offset:55296
    v_mfma_f32_16x16x32_bf16 v[60:63], v[92:95], v[156:159], v[60:63]
    ds_read_b64_tr_b16 v[90:91], v10 offset:56064
    v_mov_b32 v2, 161792
    v_mov_b32 v3, 1
    ds_write_b32 v2, v3
    s_waitcnt vmcnt(8)
    s_waitcnt lgkmcnt(10)
    v_mfma_f32_16x16x32_bf16 v[16:19], v[64:67], v[160:163], v[16:19]
    ds_read_b64_tr_b16 v[92:93], v11 offset:55328
    v_mfma_f32_16x16x32_bf16 v[20:23], v[64:67], v[164:167], v[20:23]
    ds_read_b64_tr_b16 v[94:95], v11 offset:56096
    buffer_load_dwordx4 v[200:203], v9, s[44:47], s82 offen offset:1024 sc1
    v_mfma_f32_16x16x32_bf16 v[24:27], v[68:71], v[160:163], v[24:27]
    ds_read_b64_tr_b16 v[64:65], v10 offset:55360
    v_mfma_f32_16x16x32_bf16 v[28:31], v[68:71], v[164:167], v[28:31]
    ds_read_b64_tr_b16 v[66:67], v10 offset:56128
    s_waitcnt lgkmcnt(10)
    v_mfma_f32_16x16x32_bf16 v[32:35], v[72:75], v[160:163], v[32:35]
    ds_read_b64_tr_b16 v[68:69], v11 offset:55392
    v_mfma_f32_16x16x32_bf16 v[36:39], v[72:75], v[164:167], v[36:39]
    ds_read_b64_tr_b16 v[70:71], v11 offset:56160
    buffer_load_dwordx4 v[204:207], v9, s[44:47], s83 offen offset:1024 sc1
    v_mfma_f32_16x16x32_bf16 v[40:43], v[76:79], v[160:163], v[40:43]
    ds_read_b64_tr_b16 v[72:73], v10 offset:55424
    v_mfma_f32_16x16x32_bf16 v[44:47], v[76:79], v[164:167], v[44:47]
    ds_read_b64_tr_b16 v[74:75], v10 offset:56192
    s_waitcnt lgkmcnt(10)
    v_mfma_f32_16x16x32_bf16 v[48:51], v[80:83], v[160:163], v[48:51]
    ds_read_b64_tr_b16 v[76:77], v11 offset:55456
    v_mfma_f32_16x16x32_bf16 v[52:55], v[80:83], v[164:167], v[52:55]
    ds_read_b64_tr_b16 v[78:79], v11 offset:56224
    v_mfma_f32_16x16x32_bf16 v[56:59], v[84:87], v[160:163], v[56:59]
    ds_read_b64_tr_b16 v[80:81], v12 offset:0
    v_mfma_f32_16x16x32_bf16 v[60:63], v[84:87], v[164:167], v[60:63]
    ds_read_b64_tr_b16 v[82:83], v12 offset:768
    s_waitcnt vmcnt(8)
    s_waitcnt lgkmcnt(10)
    v_mfma_f32_16x16x32_bf16 v[16:19], v[88:91], v[168:171], v[16:19]
    ds_read_b64_tr_b16 v[84:85], v13 offset:32
    v_mfma_f32_16x16x32_bf16 v[20:23], v[88:91], v[172:175], v[20:23]
    ds_read_b64_tr_b16 v[86:87], v13 offset:800
    buffer_load_dwordx4 v[208:211], v9, s[44:47], s82 offen offset:2048 sc1
    v_mfma_f32_16x16x32_bf16 v[24:27], v[92:95], v[168:171], v[24:27]
    ds_read_b64_tr_b16 v[88:89], v12 offset:64
    v_mfma_f32_16x16x32_bf16 v[28:31], v[92:95], v[172:175], v[28:31]
    ds_read_b64_tr_b16 v[90:91], v12 offset:832
    s_waitcnt lgkmcnt(10)
    v_mfma_f32_16x16x32_bf16 v[32:35], v[64:67], v[168:171], v[32:35]
    ds_read_b64_tr_b16 v[92:93], v13 offset:96
    v_mfma_f32_16x16x32_bf16 v[36:39], v[64:67], v[172:175], v[36:39]
    ds_read_b64_tr_b16 v[94:95], v13 offset:864
    buffer_load_dwordx4 v[212:215], v9, s[44:47], s83 offen offset:2048 sc1
    v_mfma_f32_16x16x32_bf16 v[40:43], v[68:71], v[168:171], v[40:43]
    ds_read_b64_tr_b16 v[64:65], v12 offset:128
    v_mfma_f32_16x16x32_bf16 v[44:47], v[68:71], v[172:175], v[44:47]
    ds_read_b64_tr_b16 v[66:67], v12 offset:896
    s_waitcnt lgkmcnt(10)
    v_mfma_f32_16x16x32_bf16 v[48:51], v[72:75], v[168:171], v[48:51]
    ds_read_b64_tr_b16 v[68:69], v13 offset:160
    v_mfma_f32_16x16x32_bf16 v[52:55], v[72:75], v[172:175], v[52:55]
    ds_read_b64_tr_b16 v[70:71], v13 offset:928
    v_mfma_f32_16x16x32_bf16 v[56:59], v[76:79], v[168:171], v[56:59]
    ds_read_b64_tr_b16 v[72:73], v12 offset:6144
    v_mfma_f32_16x16x32_bf16 v[60:63], v[76:79], v[172:175], v[60:63]
    ds_read_b64_tr_b16 v[74:75], v12 offset:6912
    s_waitcnt vmcnt(8)
    s_waitcnt lgkmcnt(10)
    v_mfma_f32_16x16x32_bf16 v[16:19], v[80:83], v[176:179], v[16:19]
    ds_read_b64_tr_b16 v[76:77], v13 offset:6176
    v_mfma_f32_16x16x32_bf16 v[20:23], v[80:83], v[180:183], v[20:23]
    ds_read_b64_tr_b16 v[78:79], v13 offset:6944
    buffer_load_dwordx4 v[216:219], v9, s[44:47], s82 offen offset:3072 sc1
    s_add_u32 s82, s82, 4096
    v_mfma_f32_16x16x32_bf16 v[24:27], v[84:87], v[176:179], v[24:27]
    ds_read_b64_tr_b16 v[80:81], v12 offset:6208
    v_mfma_f32_16x16x32_bf16 v[28:31], v[84:87], v[180:183], v[28:31]
    ds_read_b64_tr_b16 v[82:83], v12 offset:6976
    s_waitcnt lgkmcnt(10)
    v_mfma_f32_16x16x32_bf16 v[32:35], v[88:91], v[176:179], v[32:35]
    ds_read_b64_tr_b16 v[84:85], v13 offset:6240
    v_mfma_f32_16x16x32_bf16 v[36:39], v[88:91], v[180:183], v[36:39]
    ds_read_b64_tr_b16 v[86:87], v13 offset:7008
    buffer_load_dwordx4 v[220:223], v9, s[44:47], s83 offen offset:3072 sc1
    s_add_u32 s83, s83, 4096
    v_mfma_f32_16x16x32_bf16 v[40:43], v[92:95], v[176:179], v[40:43]
    ds_read_b64_tr_b16 v[88:89], v12 offset:6272
    v_mfma_f32_16x16x32_bf16 v[44:47], v[92:95], v[180:183], v[44:47]
    ds_read_b64_tr_b16 v[90:91], v12 offset:7040
    s_waitcnt lgkmcnt(10)
    v_mfma_f32_16x16x32_bf16 v[48:51], v[64:67], v[176:179], v[48:51]
    ds_read_b64_tr_b16 v[92:93], v13 offset:6304
    v_mfma_f32_16x16x32_bf16 v[52:55], v[64:67], v[180:183], v[52:55]
    ds_read_b64_tr_b16 v[94:95], v13 offset:7072
    v_mfma_f32_16x16x32_bf16 v[56:59], v[68:71], v[176:179], v[56:59]
    ds_read_b64_tr_b16 v[64:65], v12 offset:12288
    v_mfma_f32_16x16x32_bf16 v[60:63], v[68:71], v[180:183], v[60:63]
    ds_read_b64_tr_b16 v[66:67], v12 offset:13056
    s_waitcnt vmcnt(8)
    s_waitcnt lgkmcnt(10)
    v_mfma_f32_16x16x32_bf16 v[16:19], v[72:75], v[184:187], v[16:19]
    ds_read_b64_tr_b16 v[68:69], v13 offset:12320
    v_mfma_f32_16x16x32_bf16 v[20:23], v[72:75], v[188:191], v[20:23]
    ds_read_b64_tr_b16 v[70:71], v13 offset:13088
    buffer_load_dwordx4 v[224:227], v9, s[44:47], s82 offen offset:0 sc1
    v_mfma_f32_16x16x32_bf16 v[24:27], v[76:79], v[184:187], v[24:27]
    ds_read_b64_tr_b16 v[72:73], v12 offset:12352
    v_mfma_f32_16x16x32_bf16 v[28:31], v[76:79], v[188:191], v[28:31]
    ds_read_b64_tr_b16 v[74:75], v12 offset:13120
    s_waitcnt lgkmcnt(10)
    v_mfma_f32_16x16x32_bf16 v[32:35], v[80:83], v[184:187], v[32:35]
    ds_read_b64_tr_b16 v[76:77], v13 offset:12384
    v_mfma_f32_16x16x32_bf16 v[36:39], v[80:83], v[188:191], v[36:39]
    ds_read_b64_tr_b16 v[78:79], v13 offset:13152
    buffer_load_dwordx4 v[228:231], v9, s[44:47], s83 offen offset:0 sc1
    v_mfma_f32_16x16x32_bf16 v[40:43], v[84:87], v[184:187], v[40:43]
    ds_read_b64_tr_b16 v[80:81], v12 offset:12416
    v_mfma_f32_16x16x32_bf16 v[44:47], v[84:87], v[188:191], v[44:47]
    ds_read_b64_tr_b16 v[82:83], v12 offset:13184
    s_waitcnt lgkmcnt(10)
    v_mfma_f32_16x16x32_bf16 v[48:51], v[88:91], v[184:187], v[48:51]
    ds_read_b64_tr_b16 v[84:85], v13 offset:12448
    v_mfma_f32_16x16x32_bf16 v[52:55], v[88:91], v[188:191], v[52:55]
    ds_read_b64_tr_b16 v[86:87], v13 offset:13216
    v_mfma_f32_16x16x32_bf16 v[56:59], v[92:95], v[184:187], v[56:59]
    ds_read_b64_tr_b16 v[88:89], v12 offset:18432
    v_mfma_f32_16x16x32_bf16 v[60:63], v[92:95], v[188:191], v[60:63]
    ds_read_b64_tr_b16 v[90:91], v12 offset:19200
    s_waitcnt vmcnt(8)
    s_waitcnt lgkmcnt(10)
    v_mfma_f32_16x16x32_bf16 v[16:19], v[64:67], v[192:195], v[16:19]
    ds_read_b64_tr_b16 v[92:93], v13 offset:18464
    v_mfma_f32_16x16x32_bf16 v[20:23], v[64:67], v[196:199], v[20:23]
    ds_read_b64_tr_b16 v[94:95], v13 offset:19232
    buffer_load_dwordx4 v[232:235], v9, s[44:47], s82 offen offset:1024 sc1
    v_mfma_f32_16x16x32_bf16 v[24:27], v[68:71], v[192:195], v[24:27]
    ds_read_b64_tr_b16 v[64:65], v12 offset:18496
    v_mfma_f32_16x16x32_bf16 v[28:31], v[68:71], v[196:199], v[28:31]
    ds_read_b64_tr_b16 v[66:67], v12 offset:19264
    s_waitcnt lgkmcnt(10)
    v_mfma_f32_16x16x32_bf16 v[32:35], v[72:75], v[192:195], v[32:35]
    ds_read_b64_tr_b16 v[68:69], v13 offset:18528
    v_mfma_f32_16x16x32_bf16 v[36:39], v[72:75], v[196:199], v[36:39]
    ds_read_b64_tr_b16 v[70:71], v13 offset:19296
    buffer_load_dwordx4 v[236:239], v9, s[44:47], s83 offen offset:1024 sc1
    v_mfma_f32_16x16x32_bf16 v[40:43], v[76:79], v[192:195], v[40:43]
    ds_read_b64_tr_b16 v[72:73], v12 offset:18560
    v_mfma_f32_16x16x32_bf16 v[44:47], v[76:79], v[196:199], v[44:47]
    ds_read_b64_tr_b16 v[74:75], v12 offset:19328
    s_waitcnt lgkmcnt(10)
    v_mfma_f32_16x16x32_bf16 v[48:51], v[80:83], v[192:195], v[48:51]
    ds_read_b64_tr_b16 v[76:77], v13 offset:18592
    v_mfma_f32_16x16x32_bf16 v[52:55], v[80:83], v[196:199], v[52:55]
    ds_read_b64_tr_b16 v[78:79], v13 offset:19360
    v_mfma_f32_16x16x32_bf16 v[56:59], v[84:87], v[192:195], v[56:59]
    ds_read_b64_tr_b16 v[80:81], v12 offset:24576
    v_mfma_f32_16x16x32_bf16 v[60:63], v[84:87], v[196:199], v[60:63]
    ds_read_b64_tr_b16 v[82:83], v12 offset:25344
    s_waitcnt vmcnt(8)
    s_waitcnt lgkmcnt(10)
    v_mfma_f32_16x16x32_bf16 v[16:19], v[88:91], v[200:203], v[16:19]
    ds_read_b64_tr_b16 v[84:85], v13 offset:24608
    v_mfma_f32_16x16x32_bf16 v[20:23], v[88:91], v[204:207], v[20:23]
    ds_read_b64_tr_b16 v[86:87], v13 offset:25376
    buffer_load_dwordx4 v[240:243], v9, s[44:47], s82 offen offset:2048 sc1
    v_mfma_f32_16x16x32_bf16 v[24:27], v[92:95], v[200:203], v[24:27]
    ds_read_b64_tr_b16 v[88:89], v12 offset:24640
    v_mfma_f32_16x16x32_bf16 v[28:31], v[92:95], v[204:207], v[28:31]
    ds_read_b64_tr_b16 v[90:91], v12 offset:25408
    s_waitcnt lgkmcnt(10)
    v_mfma_f32_16x16x32_bf16 v[32:35], v[64:67], v[200:203], v[32:35]
    ds_read_b64_tr_b16 v[92:93], v13 offset:24672
    v_mfma_f32_16x16x32_bf16 v[36:39], v[64:67], v[204:207], v[36:39]
    ds_read_b64_tr_b16 v[94:95], v13 offset:25440
    buffer_load_dwordx4 v[244:247], v9, s[44:47], s83 offen offset:2048 sc1
    v_mfma_f32_16x16x32_bf16 v[40:43], v[68:71], v[200:203], v[40:43]
    ds_read_b64_tr_b16 v[64:65], v12 offset:24704
    v_mfma_f32_16x16x32_bf16 v[44:47], v[68:71], v[204:207], v[44:47]
    ds_read_b64_tr_b16 v[66:67], v12 offset:25472
    s_waitcnt lgkmcnt(10)
    v_mfma_f32_16x16x32_bf16 v[48:51], v[72:75], v[200:203], v[48:51]
    ds_read_b64_tr_b16 v[68:69], v13 offset:24736
    v_mfma_f32_16x16x32_bf16 v[52:55], v[72:75], v[204:207], v[52:55]
    ds_read_b64_tr_b16 v[70:71], v13 offset:25504
    v_mfma_f32_16x16x32_bf16 v[56:59], v[76:79], v[200:203], v[56:59]
    ds_read_b64_tr_b16 v[72:73], v12 offset:30720
    v_mfma_f32_16x16x32_bf16 v[60:63], v[76:79], v[204:207], v[60:63]
    ds_read_b64_tr_b16 v[74:75], v12 offset:31488
    s_waitcnt vmcnt(8)
    s_waitcnt lgkmcnt(10)
    v_mfma_f32_16x16x32_bf16 v[16:19], v[80:83], v[208:211], v[16:19]
    ds_read_b64_tr_b16 v[76:77], v13 offset:30752
    v_mfma_f32_16x16x32_bf16 v[20:23], v[80:83], v[212:215], v[20:23]
    ds_read_b64_tr_b16 v[78:79], v13 offset:31520
    buffer_load_dwordx4 v[248:251], v9, s[44:47], s82 offen offset:3072 sc1
    v_mfma_f32_16x16x32_bf16 v[24:27], v[84:87], v[208:211], v[24:27]
    ds_read_b64_tr_b16 v[80:81], v12 offset:36864
    v_mfma_f32_16x16x32_bf16 v[28:31], v[84:87], v[212:215], v[28:31]
    ds_read_b64_tr_b16 v[82:83], v12 offset:37632
    s_waitcnt lgkmcnt(10)
    v_mfma_f32_16x16x32_bf16 v[32:35], v[88:91], v[208:211], v[32:35]
    ds_read_b64_tr_b16 v[84:85], v13 offset:36896
    v_mfma_f32_16x16x32_bf16 v[36:39], v[88:91], v[212:215], v[36:39]
    ds_read_b64_tr_b16 v[86:87], v13 offset:37664
    buffer_load_dwordx4 v[252:255], v9, s[44:47], s83 offen offset:3072 sc1
    v_mfma_f32_16x16x32_bf16 v[40:43], v[92:95], v[208:211], v[40:43]
    ds_read_b64_tr_b16 v[88:89], v12 offset:43008
    v_mfma_f32_16x16x32_bf16 v[44:47], v[92:95], v[212:215], v[44:47]
    ds_read_b64_tr_b16 v[90:91], v12 offset:43776
    s_waitcnt lgkmcnt(10)
    v_mfma_f32_16x16x32_bf16 v[48:51], v[64:67], v[208:211], v[48:51]
    ds_read_b64_tr_b16 v[92:93], v13 offset:43040
    v_mfma_f32_16x16x32_bf16 v[52:55], v[64:67], v[212:215], v[52:55]
    ds_read_b64_tr_b16 v[94:95], v13 offset:43808
    v_mfma_f32_16x16x32_bf16 v[56:59], v[68:71], v[208:211], v[56:59]
    ds_read_b64_tr_b16 v[64:65], v12 offset:49152
    v_mfma_f32_16x16x32_bf16 v[60:63], v[68:71], v[212:215], v[60:63]
    ds_read_b64_tr_b16 v[66:67], v12 offset:49920
    v_mov_b32 v2, 161632
    s_mov_b32 s61, 0
fused_fww:
    ds_read_b128 v[4:7], v2
    s_add_u32 s61, s61, 1
    s_waitcnt lgkmcnt(0)
    v_readfirstlane_b32 s60, v4
    s_cmp_gt_u32 s61, 0x200000
    s_cbranch_scc1 fused_fww_d
    s_cmp_lg_u32 s60, 0
    s_cbranch_scc1 fused_fww_d
    s_sleep 1
    s_branch fused_fww
fused_fww_d:
    s_waitcnt vmcnt(8)
    s_waitcnt lgkmcnt(10)
    v_mfma_f32_16x16x32_bf16 v[16:19], v[72:75], v[216:219], v[16:19]
    ds_read_b64_tr_b16 v[68:69], v13 offset:49184
    v_mfma_f32_16x16x32_bf16 v[20:23], v[72:75], v[220:223], v[20:23]
    ds_read_b64_tr_b16 v[70:71], v13 offset:49952
    s_add_u32 s81, s74, 30720
    buffer_load_dwordx4 v[96:99], v9, s[44:47], s81 offen offset:0 sc1
    v_mfma_f32_16x16x32_bf16 v[24:27], v[76:79], v[216:219], v[24:27]
    ds_read_b64_tr_b16 v[72:73], v12 offset:55296
    v_mfma_f32_16x16x32_bf16 v[28:31], v[76:79], v[220:223], v[28:31]
    ds_read_b64_tr_b16 v[74:75], v12 offset:56064
    s_waitcnt vmcnt(7)
    s_waitcnt lgkmcnt(10)
    v_mfma_f32_16x16x32_bf16 v[16:19], v[80:83], v[224:227], v[16:19]
    ds_read_b64_tr_b16 v[76:77], v13 offset:55328
    v_mfma_f32_16x16x32_bf16 v[20:23], v[80:83], v[228:231], v[20:23]
    ds_read_b64_tr_b16 v[78:79], v13 offset:56096
    buffer_load_dwordx4 v[100:103], v9, s[44:47], s81 offen offset:1024 sc1
    v_mfma_f32_16x16x32_bf16 v[24:27], v[84:87], v[224:227], v[24:27]
    ds_read_b64_tr_b16 v[80:81], v12 offset:30784
    v_mfma_f32_16x16x32_bf16 v[28:31], v[84:87], v[228:231], v[28:31]
    ds_read_b64_tr_b16 v[82:83], v12 offset:31552
    s_waitcnt vmcnt(6)
    s_waitcnt lgkmcnt(10)
    v_mfma_f32_16x16x32_bf16 v[16:19], v[88:91], v[232:235], v[16:19]
    ds_read_b64_tr_b16 v[84:85], v13 offset:30816
    v_mfma_f32_16x16x32_bf16 v[20:23], v[88:91], v[236:239], v[20:23]
    ds_read_b64_tr_b16 v[86:87], v13 offset:31584
    buffer_load_dwordx4 v[104:107], v9, s[44:47], s81 offen offset:2048 sc1
    v_mfma_f32_16x16x32_bf16 v[24:27], v[92:95], v[232:235], v[24:27]
    ds_read_b64_tr_b16 v[88:89], v12 offset:36928
    v_mfma_f32_16x16x32_bf16 v[28:31], v[92:95], v[236:239], v[28:31]
    ds_read_b64_tr_b16 v[90:91], v12 offset:37696
    s_waitcnt vmcnt(5)
    s_waitcnt lgkmcnt(10)
    v_mfma_f32_16x16x32_bf16 v[16:19], v[64:67], v[240:243], v[16:19]
    ds_read_b64_tr_b16 v[92:93], v13 offset:36960
    v_mfma_f32_16x16x32_bf16 v[20:23], v[64:67], v[244:247], v[20:23]
    ds_read_b64_tr_b16 v[94:95], v13 offset:37728
    buffer_load_dwordx4 v[108:111], v9, s[44:47], s81 offen offset:3072 sc1
    v_mfma_f32_16x16x32_bf16 v[24:27], v[68:71], v[240:243], v[24:27]
    ds_read_b64_tr_b16 v[64:65], v12 offset:43072
    v_mfma_f32_16x16x32_bf16 v[28:31], v[68:71], v[244:247], v[28:31]
    ds_read_b64_tr_b16 v[66:67], v12 offset:43840
    s_waitcnt vmcnt(4)
    s_waitcnt lgkmcnt(10)
    v_mfma_f32_16x16x32_bf16 v[16:19], v[72:75], v[248:251], v[16:19]
    ds_read_b64_tr_b16 v[68:69], v13 offset:43104
    v_mfma_f32_16x16x32_bf16 v[20:23], v[72:75], v[252:255], v[20:23]
    ds_read_b64_tr_b16 v[70:71], v13 offset:43872
    buffer_load_dwordx4 v[112:115], v8, s[44:47], s81 offen sc1
    v_mfma_f32_16x16x32_bf16 v[24:27], v[76:79], v[248:251], v[24:27]
    ds_read_b64_tr_b16 v[72:73], v12 offset:49216
    v_mfma_f32_16x16x32_bf16 v[28:31], v[76:79], v[252:255], v[28:31]
    ds_read_b64_tr_b16 v[74:75], v12 offset:49984
    s_waitcnt lgkmcnt(10)
    v_mfma_f32_16x16x32_bf16 v[32:35], v[80:83], v[216:219], v[32:35]
    ds_read_b64_tr_b16 v[76:77], v13 offset:49248
    v_mfma_f32_16x16x32_bf16 v[36:39], v[80:83], v[220:223], v[36:39]
    ds_read_b64_tr_b16 v[78:79], v13 offset:50016
    s_add_u32 s81, s74, 35840
    buffer_load_dwordx4 v[116:119], v9, s[44:47], s81 offen offset:0 sc1
    v_mfma_f32_16x16x32_bf16 v[40:43], v[84:87], v[216:219], v[40:43]
    ds_read_b64_tr_b16 v[80:81], v12 offset:55360
    v_max_f32 v16, 0, v16
    v_max_f32 v17, 0, v17
    v_mfma_f32_16x16x32_bf16 v[44:47], v[84:87], v[220:223], v[44:47]
    ds_read_b64_tr_b16 v[82:83], v12 offset:56128
    v_max_f32 v18, 0, v18
    v_max_f32 v19, 0, v19
    s_waitcnt lgkmcnt(10)
    v_mfma_f32_16x16x32_bf16 v[32:35], v[88:91], v[224:227], v[32:35]
    ds_read_b64_tr_b16 v[84:85], v13 offset:55392
    v_mul_f32 v16, v16, v16
    v_mul_f32 v17, v17, v17
    v_mfma_f32_16x16x32_bf16 v[36:39], v[88:91], v[228:231], v[36:39]
    ds_read_b64_tr_b16 v[86:87], v13 offset:56160
    v_mul_f32 v18, v18, v18
    v_mul_f32 v19, v19, v19
    v_mfma_f32_16x16x32_bf16 v[40:43], v[92:95], v[224:227], v[40:43]
    ds_read_b64_tr_b16 v[88:89], v12 offset:30848
    v_max_f32 v24, 0, v24
    v_max_f32 v25, 0, v25
    v_mfma_f32_16x16x32_bf16 v[44:47], v[92:95], v[228:231], v[44:47]
    ds_read_b64_tr_b16 v[90:91], v12 offset:31616
    v_max_f32 v26, 0, v26
    v_max_f32 v27, 0, v27
    s_waitcnt lgkmcnt(10)
    v_mfma_f32_16x16x32_bf16 v[32:35], v[64:67], v[232:235], v[32:35]
    ds_read_b64_tr_b16 v[92:93], v13 offset:30880
    v_mul_f32 v24, v24, v24
    v_mul_f32 v25, v25, v25
    v_mfma_f32_16x16x32_bf16 v[36:39], v[64:67], v[236:239], v[36:39]
    ds_read_b64_tr_b16 v[94:95], v13 offset:31648
    v_mul_f32 v26, v26, v26
    v_mul_f32 v27, v27, v27
    v_mfma_f32_16x16x32_bf16 v[40:43], v[68:71], v[232:235], v[40:43]
    ds_read_b64_tr_b16 v[64:65], v12 offset:36992
    v_cvt_pk_bf16_f32 v16, v16, v17
    v_cvt_pk_bf16_f32 v17, v18, v19
    v_mfma_f32_16x16x32_bf16 v[44:47], v[68:71], v[236:239], v[44:47]
    ds_read_b64_tr_b16 v[66:67], v12 offset:37760
    v_cvt_pk_bf16_f32 v18, v24, v25
    v_cvt_pk_bf16_f32 v19, v26, v27
    s_waitcnt lgkmcnt(10)
    v_mfma_f32_16x16x32_bf16 v[32:35], v[72:75], v[240:243], v[32:35]
    ds_read_b64_tr_b16 v[68:69], v13 offset:37024
    buffer_store_dwordx4 v[16:19], v9, s[44:47], s86 offen offset:0 sc1
    v_max_f32 v20, 0, v20
    v_mfma_f32_16x16x32_bf16 v[36:39], v[72:75], v[244:247], v[36:39]
    ds_read_b64_tr_b16 v[70:71], v13 offset:37792
    v_max_f32 v21, 0, v21
    v_max_f32 v22, 0, v22
    v_mfma_f32_16x16x32_bf16 v[40:43], v[76:79], v[240:243], v[40:43]
    ds_read_b64_tr_b16 v[72:73], v12 offset:43136
    v_max_f32 v23, 0, v23
    v_mul_f32 v20, v20, v20
    v_mfma_f32_16x16x32_bf16 v[44:47], v[76:79], v[244:247], v[44:47]
    ds_read_b64_tr_b16 v[74:75], v12 offset:43904
    v_mul_f32 v21, v21, v21
    v_mul_f32 v22, v22, v22
    s_waitcnt lgkmcnt(10)
    v_mfma_f32_16x16x32_bf16 v[32:35], v[80:83], v[248:251], v[32:35]
    ds_read_b64_tr_b16 v[76:77], v13 offset:43168
    v_mul_f32 v23, v23, v23
    v_max_f32 v28, 0, v28
    v_mfma_f32_16x16x32_bf16 v[36:39], v[80:83], v[252:255], v[36:39]
    ds_read_b64_tr_b16 v[78:79], v13 offset:43936
    v_max_f32 v29, 0, v29
    v_max_f32 v30, 0, v30
    v_mfma_f32_16x16x32_bf16 v[40:43], v[84:87], v[248:251], v[40:43]
    ds_read_b64_tr_b16 v[80:81], v12 offset:49280
    v_max_f32 v31, 0, v31
    v_mul_f32 v28, v28, v28
    v_mfma_f32_16x16x32_bf16 v[44:47], v[84:87], v[252:255], v[44:47]
    ds_read_b64_tr_b16 v[82:83], v12 offset:50048
    v_mul_f32 v29, v29, v29
    v_mul_f32 v30, v30, v30
    s_waitcnt lgkmcnt(10)
    v_mfma_f32_16x16x32_bf16 v[48:51], v[88:91], v[216:219], v[48:51]
    ds_read_b64_tr_b16 v[84:85], v13 offset:49312
    v_mul_f32 v31, v31, v31
    v_cvt_pk_bf16_f32 v20, v20, v21
    v_mfma_f32_16x16x32_bf16 v[52:55], v[88:91], v[220:223], v[52:55]
    ds_read_b64_tr_b16 v[86:87], v13 offset:50080
    v_cvt_pk_bf16_f32 v21, v22, v23
    v_cvt_pk_bf16_f32 v22, v28, v29
    v_mfma_f32_16x16x32_bf16 v[56:59], v[92:95], v[216:219], v[56:59]
    ds_read_b64_tr_b16 v[88:89], v12 offset:55424
    v_cvt_pk_bf16_f32 v23, v30, v31
    buffer_store_dwordx4 v[20:23], v9, s[44:47], s87 offen offset:0 sc1
    v_mfma_f32_16x16x32_bf16 v[60:63], v[92:95], v[220:223], v[60:63]
    ds_read_b64_tr_b16 v[90:91], v12 offset:56192
    v_max_f32 v32, 0, v32
    v_max_f32 v33, 0, v33
    s_waitcnt lgkmcnt(10)
    v_mfma_f32_16x16x32_bf16 v[48:51], v[64:67], v[224:227], v[48:51]
    ds_read_b64_tr_b16 v[92:93], v13 offset:55456
    v_max_f32 v34, 0, v34
    v_max_f32 v35, 0, v35
    v_mfma_f32_16x16x32_bf16 v[52:55], v[64:67], v[228:231], v[52:55]
    ds_read_b64_tr_b16 v[94:95], v13 offset:56224
    v_mul_f32 v32, v32, v32
    v_mul_f32 v33, v33, v33
    v_mfma_f32_16x16x32_bf16 v[56:59], v[68:71], v[224:227], v[56:59]
    v_mul_f32 v34, v34, v34
    v_mul_f32 v35, v35, v35
    v_max_f32 v40, 0, v40
    v_mfma_f32_16x16x32_bf16 v[60:63], v[68:71], v[228:231], v[60:63]
    v_max_f32 v41, 0, v41
    v_max_f32 v42, 0, v42
    v_max_f32 v43, 0, v43
    s_waitcnt lgkmcnt(8)
    v_mfma_f32_16x16x32_bf16 v[48:51], v[72:75], v[232:235], v[48:51]
    v_mul_f32 v40, v40, v40
    v_mul_f32 v41, v41, v41
    v_mul_f32 v42, v42, v42
    v_mfma_f32_16x16x32_bf16 v[52:55], v[72:75], v[236:239], v[52:55]
    v_mul_f32 v43, v43, v43
    v_cvt_pk_bf16_f32 v32, v32, v33
    v_cvt_pk_bf16_f32 v33, v34, v35
    v_mfma_f32_16x16x32_bf16 v[56:59], v[76:79], v[232:235], v[56:59]
    v_cvt_pk_bf16_f32 v34, v40, v41
    v_cvt_pk_bf16_f32 v35, v42, v43
    buffer_store_dwordx4 v[32:35], v9, s[44:47], s86 offen offset:1024 sc1
    v_mfma_f32_16x16x32_bf16 v[60:63], v[76:79], v[236:239], v[60:63]
    v_max_f32 v36, 0, v36
    v_max_f32 v37, 0, v37
    v_max_f32 v38, 0, v38
    s_waitcnt lgkmcnt(4)
    v_mfma_f32_16x16x32_bf16 v[48:51], v[80:83], v[240:243], v[48:51]
    v_max_f32 v39, 0, v39
    v_mul_f32 v36, v36, v36
    v_mul_f32 v37, v37, v37
    v_mfma_f32_16x16x32_bf16 v[52:55], v[80:83], v[244:247], v[52:55]
    v_mul_f32 v38, v38, v38
    v_mul_f32 v39, v39, v39
    v_max_f32 v44, 0, v44
    v_mfma_f32_16x16x32_bf16 v[56:59], v[84:87], v[240:243], v[56:59]
    v_max_f32 v45, 0, v45
    v_max_f32 v46, 0, v46
    v_max_f32 v47, 0, v47
    v_mfma_f32_16x16x32_bf16 v[60:63], v[84:87], v[244:247], v[60:63]
    v_mul_f32 v44, v44, v44
    v_mul_f32 v45, v45, v45
    v_mul_f32 v46, v46, v46
    s_waitcnt lgkmcnt(0)
    v_mfma_f32_16x16x32_bf16 v[48:51], v[88:91], v[248:251], v[48:51]
    v_mul_f32 v47, v47, v47
    v_cvt_pk_bf16_f32 v36, v36, v37
    v_cvt_pk_bf16_f32 v37, v38, v39
    v_mfma_f32_16x16x32_bf16 v[52:55], v[88:91], v[252:255], v[52:55]
    v_cvt_pk_bf16_f32 v38, v44, v45
    v_cvt_pk_bf16_f32 v39, v46, v47
    buffer_store_dwordx4 v[36:39], v9, s[44:47], s87 offen offset:1024 sc1
    v_mfma_f32_16x16x32_bf16 v[56:59], v[92:95], v[248:251], v[56:59]
    v_mfma_f32_16x16x32_bf16 v[60:63], v[92:95], v[252:255], v[60:63]
    v_mov_b32 v2, 161696
    v_mov_b32 v3, 1
    s_mov_b64 exec, 1
    ds_add_u32 v2, v3
    s_mov_b64 exec, -1
    v_max_f32 v48, 0, v48
    v_max_f32 v49, 0, v49
    v_max_f32 v50, 0, v50
    v_max_f32 v51, 0, v51
    v_mul_f32 v48, v48, v48
    v_mul_f32 v49, v49, v49
    v_mul_f32 v50, v50, v50
    v_mul_f32 v51, v51, v51
    v_max_f32 v56, 0, v56
    v_max_f32 v57, 0, v57
    v_max_f32 v58, 0, v58
    v_max_f32 v59, 0, v59
    v_mul_f32 v56, v56, v56
    v_mul_f32 v57, v57, v57
    v_mul_f32 v58, v58, v58
    v_mul_f32 v59, v59, v59
    v_cvt_pk_bf16_f32 v48, v48, v49
    v_cvt_pk_bf16_f32 v49, v50, v51
    v_cvt_pk_bf16_f32 v50, v56, v57
    v_cvt_pk_bf16_f32 v51, v58, v59
    buffer_store_dwordx4 v[48:51], v9, s[44:47], s86 offen offset:2048 sc1
    v_max_f32 v52, 0, v52
    v_max_f32 v53, 0, v53
    v_max_f32 v54, 0, v54
    v_max_f32 v55, 0, v55
    v_mul_f32 v52, v52, v52
    v_mul_f32 v53, v53, v53
    v_mul_f32 v54, v54, v54
    v_mul_f32 v55, v55, v55
    v_max_f32 v60, 0, v60
    v_max_f32 v61, 0, v61
    v_max_f32 v62, 0, v62
    v_max_f32 v63, 0, v63
    v_mul_f32 v60, v60, v60
    v_mul_f32 v61, v61, v61
    v_mul_f32 v62, v62, v62
    v_mul_f32 v63, v63, v63
    v_cvt_pk_bf16_f32 v52, v52, v53
    v_cvt_pk_bf16_f32 v53, v54, v55
    v_cvt_pk_bf16_f32 v54, v60, v61
    v_cvt_pk_bf16_f32 v55, v62, v63
    buffer_store_dwordx4 v[52:55], v9, s[44:47], s87 offen offset:2048 sc1
    buffer_load_dwordx4 v[120:123], v9, s[44:47], s81 offen offset:1024 sc1
    buffer_load_dwordx4 v[124:127], v9, s[44:47], s81 offen offset:2048 sc1
    buffer_load_dwordx4 v[128:131], v9, s[44:47], s81 offen offset:3072 sc1
    buffer_load_dwordx4 v[132:135], v8, s[44:47], s81 offen sc1
    v_add_u32 v10, s75, v9
    v_add_u32 v13, 8192, v9
    s_waitcnt vmcnt(4)
    v_mov_b32 v2, 161712
    v_mov_b32 v3, 1
    s_mov_b64 exec, 1
    ds_add_rtn_u32 v4, v2, v3
    s_mov_b64 exec, -1
    s_mul_i32 s66, s93, 128
    s_add_u32 s66, s66, 16285696
    s_waitcnt lgkmcnt(0)
    s_nop 1
    v_readfirstlane_b32 s60, v4
    s_nop 1
    s_cmp_lg_u32 s60, 3
    s_cbranch_scc1 fused_nofh0
    v_mov_b32 v2, s96
    s_mov_b64 s[62:63], exec
    s_mov_b64 exec, 1
    buffer_store_dword v2, off, s[44:47], s66 sc1
    s_mov_b64 exec, s[62:63]
fused_nofh0:
    s_add_u32 s81, s74, 40960
    buffer_load_dwordx4 v[136:139], v9, s[44:47], s81 offen offset:0 sc1
    buffer_load_dwordx4 v[140:143], v9, s[44:47], s81 offen offset:1024 sc1
    buffer_load_dwordx4 v[144:147], v9, s[44:47], s81 offen offset:2048 sc1
    buffer_load_dwordx4 v[148:151], v9, s[44:47], s81 offen offset:3072 sc1
    buffer_load_dwordx4 v[152:155], v8, s[44:47], s81 offen sc1
    v_mov_b32 v2, 161696
    s_mov_b32 s61, 0
fused_pdw:
    ds_read_b32 v3, v2
    s_add_u32 s61, s61, 1
    s_waitcnt lgkmcnt(0)
    v_readfirstlane_b32 s60, v3
    s_cmp_gt_u32 s61, 0x200000
    s_cbranch_scc1 fused_pdw_d
    s_cmp_lt_u32 s60, 4
    s_cbranch_scc1 fused_pdw
fused_pdw_d:
    s_setprio 0
    s_add_u32 s81, s74, 0
    s_add_u32 m0, s75, 0
    s_nop 0
    buffer_load_dwordx4 v9, s[44:47], s81 offen offset:0 sc1 lds
    s_add_u32 m0, s75, 0
    s_nop 0
    buffer_load_dwordx4 v9, s[44:47], s81 offen offset:1024 sc1 lds
    s_add_u32 m0, s75, 0
    s_nop 0
    buffer_load_dwordx4 v9, s[44:47], s81 offen offset:2048 sc1 lds
    s_add_u32 m0, s75, 0
    s_nop 0
    buffer_load_dwordx4 v9, s[44:47], s81 offen offset:3072 sc1 lds
    s_add_u32 m0, s75, 4096
    s_nop 0
    buffer_load_dwordx4 v8, s[44:47], s81 offen sc1 lds
    s_add_u32 s81, s74, 5120
    s_add_u32 m0, s75, 5120
    s_nop 0
    buffer_load_dwordx4 v9, s[44:47], s81 offen offset:0 sc1 lds
    s_add_u32 m0, s75, 5120
    s_nop 0
    buffer_load_dwordx4 v9, s[44:47], s81 offen offset:1024 sc1 lds
    s_add_u32 m0, s75, 5120
    s_nop 0
    buffer_load_dwordx4 v9, s[44:47], s81 offen offset:2048 sc1 lds
    s_add_u32 m0, s75, 5120
    s_nop 0
    buffer_load_dwordx4 v9, s[44:47], s81 offen offset:3072 sc1 lds
    s_add_u32 m0, s75, 9216
    s_nop 0
    buffer_load_dwordx4 v8, s[44:47], s81 offen sc1 lds
    s_add_u32 s81, s74, 10240
    s_add_u32 m0, s75, 10240
    s_nop 0
    buffer_load_dwordx4 v9, s[44:47], s81 offen offset:0 sc1 lds
    s_add_u32 m0, s75, 10240
    s_nop 0
    buffer_load_dwordx4 v9, s[44:47], s81 offen offset:1024 sc1 lds
    s_add_u32 m0, s75, 10240
    s_nop 0
    buffer_load_dwordx4 v9, s[44:47], s81 offen offset:2048 sc1 lds
    s_add_u32 m0, s75, 10240
    s_nop 0
    buffer_load_dwordx4 v9, s[44:47], s81 offen offset:3072 sc1 lds
    s_add_u32 m0, s75, 14336
    s_nop 0
    buffer_load_dwordx4 v8, s[44:47], s81 offen sc1 lds
    s_add_u32 s81, s74, 15360
    s_add_u32 m0, s75, 15360
    s_nop 0
    buffer_load_dwordx4 v9, s[44:47], s81 offen offset:0 sc1 lds
    s_add_u32 m0, s75, 15360
    s_nop 0
    buffer_load_dwordx4 v9, s[44:47], s81 offen offset:1024 sc1 lds
    s_add_u32 m0, s75, 15360
    s_nop 0
    buffer_load_dwordx4 v9, s[44:47], s81 offen offset:2048 sc1 lds
    s_add_u32 m0, s75, 15360
    s_nop 0
    buffer_load_dwordx4 v9, s[44:47], s81 offen offset:3072 sc1 lds
    s_add_u32 m0, s75, 19456
    s_nop 0
    buffer_load_dwordx4 v8, s[44:47], s81 offen sc1 lds
    s_add_u32 s81, s74, 20480
    s_add_u32 m0, s75, 20480
    s_nop 0
    buffer_load_dwordx4 v9, s[44:47], s81 offen offset:0 sc1 lds
    s_add_u32 m0, s75, 20480
    s_nop 0
    buffer_load_dwordx4 v9, s[44:47], s81 offen offset:1024 sc1 lds
    s_add_u32 m0, s75, 20480
    s_nop 0
    buffer_load_dwordx4 v9, s[44:47], s81 offen offset:2048 sc1 lds
    s_add_u32 m0, s75, 20480
    s_nop 0
    buffer_load_dwordx4 v9, s[44:47], s81 offen offset:3072 sc1 lds
    s_add_u32 m0, s75, 24576
    s_nop 0
    buffer_load_dwordx4 v8, s[44:47], s81 offen sc1 lds
    s_add_u32 s81, s74, 25600
    s_add_u32 m0, s75, 25600
    s_nop 0
    buffer_load_dwordx4 v9, s[44:47], s81 offen offset:0 sc1 lds
    s_add_u32 m0, s75, 25600
    s_nop 0
    buffer_load_dwordx4 v9, s[44:47], s81 offen offset:1024 sc1 lds
    s_add_u32 m0, s75, 25600
    s_nop 0
    buffer_load_dwordx4 v9, s[44:47], s81 offen offset:2048 sc1 lds
    s_add_u32 m0, s75, 25600
    s_nop 0
    buffer_load_dwordx4 v9, s[44:47], s81 offen offset:3072 sc1 lds
    s_add_u32 m0, s75, 29696
    s_nop 0
    buffer_load_dwordx4 v8, s[44:47], s81 offen sc1 lds
    s_lshr_b32 s66, s39, 1
    s_lshl_b32 s66, s66, 2
    s_add_u32 s66, s66, s34
    s_mul_i32 s66, s66, 512
    s_add_u32 s66, s66, 16285696
    s_add_u32 s62, s32, s66
    s_addc_u32 s63, s33, 0
    s_mov_b32 s64, 0
fused_pfh:
    s_load_dword s4, s[62:63], 0 glc
    s_load_dword s5, s[62:63], 128 glc
    s_load_dword s6, s[62:63], 256 glc
    s_load_dword s7, s[62:63], 384 glc
    s_add_u32 s64, s64, 1
    s_waitcnt lgkmcnt(0)
    s_xor_b32 s4, s4, s96
    s_xor_b32 s5, s5, s96
    s_xor_b32 s6, s6, s96
    s_xor_b32 s7, s7, s96
    s_or_b32 s4, s4, s5
    s_or_b32 s6, s6, s7
    s_or_b32 s4, s4, s6
    s_cmp_eq_u32 s4, 0
    s_cbranch_scc1 fused_pfh_d
    s_sleep 1
    s_cmp_lt_u32 s64, 0x20000
    s_cbranch_scc1 fused_pfh
fused_pfh_d:
    buffer_load_dwordx4 v[176:179], v9, s[44:47], s76 offen offset:0 sc1
    buffer_load_dwordx4 v[180:183], v9, s[44:47], s77 offen offset:0 sc1
    buffer_load_dwordx4 v[184:187], v9, s[44:47], s78 offen offset:0 sc1
    buffer_load_dwordx4 v[188:191], v9, s[44:47], s79 offen offset:0 sc1
    buffer_load_dwordx4 v[192:195], v9, s[44:47], s76 offen offset:1024 sc1
    buffer_load_dwordx4 v[196:199], v9, s[44:47], s77 offen offset:1024 sc1
    buffer_load_dwordx4 v[200:203], v9, s[44:47], s78 offen offset:1024 sc1
    buffer_load_dwordx4 v[204:207], v9, s[44:47], s79 offen offset:1024 sc1
    s_waitcnt vmcnt(33)
    ds_read_b128 v[156:159], v10 offset:0
    ds_read_b128 v[160:163], v10 offset:1024
    ds_read_b128 v[164:167], v10 offset:2048
    ds_read_b128 v[168:171], v10 offset:3072
    s_waitcnt vmcnt(4)
    s_waitcnt lgkmcnt(3)
    v_mfma_f32_16x16x32_bf16 v[16:19], v[156:159], v[176:179], 0
    buffer_load_dwordx4 v[208:211], v9, s[44:47], s76 offen offset:2048 sc1
    v_mfma_f32_16x16x32_bf16 v[20:23], v[156:159], v[180:183], 0
    ds_read_b128 v[172:175], v10 offset:4096
    v_mfma_f32_16x16x32_bf16 v[24:27], v[156:159], v[184:187], 0
    buffer_load_dwordx4 v[212:215], v9, s[44:47], s77 offen offset:2048 sc1
    v_mfma_f32_16x16x32_bf16 v[28:31], v[156:159], v[188:191], 0
    s_waitcnt lgkmcnt(3)
    v_mfma_f32_16x16x32_bf16 v[32:35], v[160:163], v[176:179], 0
    buffer_load_dwordx4 v[216:219], v9, s[44:47], s78 offen offset:2048 sc1
    v_mfma_f32_16x16x32_bf16 v[36:39], v[160:163], v[180:183], 0
    ds_read_b128 v[156:159], v10 offset:5120
    v_mfma_f32_16x16x32_bf16 v[40:43], v[160:163], v[184:187], 0
    buffer_load_dwordx4 v[220:223], v9, s[44:47], s79 offen offset:2048 sc1
    v_mfma_f32_16x16x32_bf16 v[44:47], v[160:163], v[188:191], 0
    s_waitcnt lgkmcnt(3)
    v_mfma_f32_16x16x32_bf16 v[48:51], v[164:167], v[176:179], 0
    buffer_load_dwordx4 v[224:227], v9, s[44:47], s76 offen offset:3072 sc1
    v_mfma_f32_16x16x32_bf16 v[52:55], v[164:167], v[180:183], 0
    ds_read_b128 v[160:163], v10 offset:6144
    v_mfma_f32_16x16x32_bf16 v[56:59], v[164:167], v[184:187], 0
    buffer_load_dwordx4 v[228:231], v9, s[44:47], s77 offen offset:3072 sc1
    v_mfma_f32_16x16x32_bf16 v[60:63], v[164:167], v[188:191], 0
    s_waitcnt lgkmcnt(3)
    v_mfma_f32_16x16x32_bf16 v[64:67], v[168:171], v[176:179], 0
    buffer_load_dwordx4 v[232:235], v9, s[44:47], s78 offen offset:3072 sc1
    v_mfma_f32_16x16x32_bf16 v[68:71], v[168:171], v[180:183], 0
    ds_read_b128 v[164:167], v10 offset:7168
    v_mfma_f32_16x16x32_bf16 v[72:75], v[168:171], v[184:187], 0
    buffer_load_dwordx4 v[236:239], v9, s[44:47], s79 offen offset:3072 sc1
    v_mfma_f32_16x16x32_bf16 v[76:79], v[168:171], v[188:191], 0
    s_waitcnt lgkmcnt(3)
    v_mfma_f32_16x16x32_bf16 v[80:83], v[172:175], v[176:179], 0
    buffer_load_dwordx4 v[240:243], v8, s[44:47], s76 offen offset:0 sc1
    v_mfma_f32_16x16x32_bf16 v[84:87], v[172:175], v[180:183], 0
    ds_read_b128 v[168:171], v10 offset:8192
    v_mfma_f32_16x16x32_bf16 v[88:91], v[172:175], v[184:187], 0
    buffer_load_dwordx4 v[244:247], v8, s[44:47], s77 offen offset:0 sc1
    v_mfma_f32_16x16x32_bf16 v[92:95], v[172:175], v[188:191], 0
    s_waitcnt vmcnt(10)
    s_waitcnt lgkmcnt(3)
    v_mfma_f32_16x16x32_bf16 v[16:19], v[156:159], v[192:195], v[16:19]
    buffer_load_dwordx4 v[176:179], v8, s[44:47], s76 offen offset:1024 sc1
    v_mfma_f32_16x16x32_bf16 v[20:23], v[156:159], v[196:199], v[20:23]
    ds_read_b128 v[172:175], v10 offset:9216
    v_mfma_f32_16x16x32_bf16 v[24:27], v[156:159], v[200:203], v[24:27]
    buffer_load_dwordx4 v[180:183], v8, s[44:47], s77 offen offset:1024 sc1
    v_mfma_f32_16x16x32_bf16 v[28:31], v[156:159], v[204:207], v[28:31]
    s_waitcnt lgkmcnt(3)
    v_mfma_f32_16x16x32_bf16 v[32:35], v[160:163], v[192:195], v[32:35]
    buffer_load_dwordx4 v[184:187], v8, s[44:47], s78 offen offset:1024 sc1
    v_mfma_f32_16x16x32_bf16 v[36:39], v[160:163], v[196:199], v[36:39]
    ds_read_b128 v[156:159], v10 offset:10240
    v_mfma_f32_16x16x32_bf16 v[40:43], v[160:163], v[200:203], v[40:43]
    buffer_load_dwordx4 v[188:191], v8, s[44:47], s79 offen offset:1024 sc1
    v_mfma_f32_16x16x32_bf16 v[44:47], v[160:163], v[204:207], v[44:47]
    s_waitcnt lgkmcnt(3)
    v_mfma_f32_16x16x32_bf16 v[48:51], v[164:167], v[192:195], v[48:51]
    buffer_load_dwordx4 v[248:251], v8, s[44:47], s78 offen offset:0 sc1
    v_mfma_f32_16x16x32_bf16 v[52:55], v[164:167], v[196:199], v[52:55]
    ds_read_b128 v[160:163], v10 offset:11264
    v_mfma_f32_16x16x32_bf16 v[56:59], v[164:167], v[200:203], v[56:59]
    buffer_load_dwordx4 v[252:255], v8, s[44:47], s79 offen offset:0 sc1
    v_mfma_f32_16x16x32_bf16 v[60:63], v[164:167], v[204:207], v[60:63]
    s_waitcnt lgkmcnt(3)
    v_mfma_f32_16x16x32_bf16 v[64:67], v[168:171], v[192:195], v[64:67]
    s_add_u32 s81, s74, 46080
    s_add_u32 m0, s75, 0
    s_nop 0
    buffer_load_dwordx4 v9, s[44:47], s81 offen offset:0 sc1 lds
    v_mfma_f32_16x16x32_bf16 v[68:71], v[168:171], v[196:199], v[68:71]
    ds_read_b128 v[164:167], v10 offset:12288
    v_mfma_f32_16x16x32_bf16 v[72:75], v[168:171], v[200:203], v[72:75]
    s_add_u32 m0, s75, 0
    s_nop 0
    buffer_load_dwordx4 v9, s[44:47], s81 offen offset:1024 sc1 lds
    v_mfma_f32_16x16x32_bf16 v[76:79], v[168:171], v[204:207], v[76:79]
    s_waitcnt lgkmcnt(3)
    v_mfma_f32_16x16x32_bf16 v[80:83], v[172:175], v[192:195], v[80:83]
    s_add_u32 m0, s75, 0
    s_nop 0
    buffer_load_dwordx4 v9, s[44:47], s81 offen offset:2048 sc1 lds
    v_mfma_f32_16x16x32_bf16 v[84:87], v[172:175], v[196:199], v[84:87]
    ds_read_b128 v[168:171], v10 offset:13312
    v_mfma_f32_16x16x32_bf16 v[88:91], v[172:175], v[200:203], v[88:91]
    s_add_u32 m0, s75, 0
    s_nop 0
    buffer_load_dwordx4 v9, s[44:47], s81 offen offset:3072 sc1 lds
    v_mfma_f32_16x16x32_bf16 v[92:95], v[172:175], v[204:207], v[92:95]
    s_waitcnt vmcnt(16)
    s_waitcnt lgkmcnt(3)
    v_mfma_f32_16x16x32_bf16 v[16:19], v[156:159], v[208:211], v[16:19]
    buffer_load_dwordx4 v[192:195], v8, s[44:47], s76 offen offset:2048 sc1
    v_mfma_f32_16x16x32_bf16 v[20:23], v[156:159], v[212:215], v[20:23]
    ds_read_b128 v[172:175], v10 offset:14336
    v_mfma_f32_16x16x32_bf16 v[24:27], v[156:159], v[216:219], v[24:27]
    buffer_load_dwordx4 v[196:199], v8, s[44:47], s77 offen offset:2048 sc1
    v_mfma_f32_16x16x32_bf16 v[28:31], v[156:159], v[220:223], v[28:31]
    s_waitcnt lgkmcnt(3)
    v_mfma_f32_16x16x32_bf16 v[32:35], v[160:163], v[208:211], v[32:35]
    buffer_load_dwordx4 v[200:203], v8, s[44:47], s78 offen offset:2048 sc1
    v_mfma_f32_16x16x32_bf16 v[36:39], v[160:163], v[212:215], v[36:39]
    ds_read_b128 v[156:159], v10 offset:15360
    v_mfma_f32_16x16x32_bf16 v[40:43], v[160:163], v[216:219], v[40:43]
    buffer_load_dwordx4 v[204:207], v8, s[44:47], s79 offen offset:2048 sc1
    v_mfma_f32_16x16x32_bf16 v[44:47], v[160:163], v[220:223], v[44:47]
    s_waitcnt lgkmcnt(3)
    v_mfma_f32_16x16x32_bf16 v[48:51], v[164:167], v[208:211], v[48:51]
    s_add_u32 m0, s75, 4096
    s_nop 0
    buffer_load_dwordx4 v8, s[44:47], s81 offen sc1 lds
    v_mfma_f32_16x16x32_bf16 v[52:55], v[164:167], v[212:215], v[52:55]
    ds_read_b128 v[160:163], v10 offset:16384
    v_mfma_f32_16x16x32_bf16 v[56:59], v[164:167], v[216:219], v[56:59]
    s_add_u32 s81, s74, 51200
    s_add_u32 m0, s75, 5120
    s_nop 0
    buffer_load_dwordx4 v9, s[44:47], s81 offen offset:0 sc1 lds
    v_mfma_f32_16x16x32_bf16 v[60:63], v[164:167], v[220:223], v[60:63]
    s_waitcnt lgkmcnt(3)
    v_mfma_f32_16x16x32_bf16 v[64:67], v[168:171], v[208:211], v[64:67]
    s_add_u32 m0, s75, 5120
    s_nop 0
    buffer_load_dwordx4 v9, s[44:47], s81 offen offset:1024 sc1 lds
    v_mfma_f32_16x16x32_bf16 v[68:71], v[168:171], v[212:215], v[68:71]
    ds_read_b128 v[164:167], v10 offset:17408
    v_mfma_f32_16x16x32_bf16 v[72:75], v[168:171], v[216:219], v[72:75]
    s_add_u32 m0, s75, 5120
    s_nop 0
    buffer_load_dwordx4 v9, s[44:47], s81 offen offset:2048 sc1 lds
    v_mfma_f32_16x16x32_bf16 v[76:79], v[168:171], v[220:223], v[76:79]
    s_waitcnt lgkmcnt(3)
    v_mfma_f32_16x16x32_bf16 v[80:83], v[172:175], v[208:211], v[80:83]
    s_add_u32 m0, s75, 5120
    s_nop 0
    buffer_load_dwordx4 v9, s[44:47], s81 offen offset:3072 sc1 lds
    v_mfma_f32_16x16x32_bf16 v[84:87], v[172:175], v[212:215], v[84:87]
    ds_read_b128 v[168:171], v10 offset:18432
    v_mfma_f32_16x16x32_bf16 v[88:91], v[172:175], v[216:219], v[88:91]
    s_add_u32 m0, s75, 9216
    s_nop 0
    buffer_load_dwordx4 v8, s[44:47], s81 offen sc1 lds
    v_mfma_f32_16x16x32_bf16 v[92:95], v[172:175], v[220:223], v[92:95]
    s_waitcnt vmcnt(22)
    s_waitcnt lgkmcnt(3)
    v_mfma_f32_16x16x32_bf16 v[16:19], v[156:159], v[224:227], v[16:19]
    buffer_load_dwordx4 v[208:211], v8, s[44:47], s76 offen offset:3072 sc1
    v_mfma_f32_16x16x32_bf16 v[20:23], v[156:159], v[228:231], v[20:23]
    ds_read_b128 v[172:175], v10 offset:19456
    v_mfma_f32_16x16x32_bf16 v[24:27], v[156:159], v[232:235], v[24:27]
    buffer_load_dwordx4 v[212:215], v8, s[44:47], s77 offen offset:3072 sc1
    v_mfma_f32_16x16x32_bf16 v[28:31], v[156:159], v[236:239], v[28:31]
    s_waitcnt lgkmcnt(3)
    v_mfma_f32_16x16x32_bf16 v[32:35], v[160:163], v[224:227], v[32:35]
    buffer_load_dwordx4 v[216:219], v8, s[44:47], s78 offen offset:3072 sc1
    v_mfma_f32_16x16x32_bf16 v[36:39], v[160:163], v[228:231], v[36:39]
    ds_read_b128 v[156:159], v10 offset:20480
    v_mfma_f32_16x16x32_bf16 v[40:43], v[160:163], v[232:235], v[40:43]
    buffer_load_dwordx4 v[220:223], v8, s[44:47], s79 offen offset:3072 sc1
    v_mfma_f32_16x16x32_bf16 v[44:47], v[160:163], v[236:239], v[44:47]
    s_waitcnt lgkmcnt(3)
    v_mfma_f32_16x16x32_bf16 v[48:51], v[164:167], v[224:227], v[48:51]
    s_add_u32 s81, s74, 56320
    s_add_u32 m0, s75, 10240
    s_nop 0
    buffer_load_dwordx4 v9, s[44:47], s81 offen offset:0 sc1 lds
    v_mfma_f32_16x16x32_bf16 v[52:55], v[164:167], v[228:231], v[52:55]
    ds_read_b128 v[160:163], v10 offset:21504
    v_mfma_f32_16x16x32_bf16 v[56:59], v[164:167], v[232:235], v[56:59]
    s_add_u32 m0, s75, 10240
    s_nop 0
    buffer_load_dwordx4 v9, s[44:47], s81 offen offset:1024 sc1 lds
    v_mfma_f32_16x16x32_bf16 v[60:63], v[164:167], v[236:239], v[60:63]
    s_waitcnt lgkmcnt(3)
    v_mfma_f32_16x16x32_bf16 v[64:67], v[168:171], v[224:227], v[64:67]
    s_add_u32 m0, s75, 10240
    s_nop 0
    buffer_load_dwordx4 v9, s[44:47], s81 offen offset:2048 sc1 lds
    v_mfma_f32_16x16x32_bf16 v[68:71], v[168:171], v[228:231], v[68:71]
    ds_read_b128 v[164:167], v10 offset:22528
    v_mfma_f32_16x16x32_bf16 v[72:75], v[168:171], v[232:235], v[72:75]
    s_add_u32 m0, s75, 10240
    s_nop 0
    buffer_load_dwordx4 v9, s[44:47], s81 offen offset:3072 sc1 lds
    v_mfma_f32_16x16x32_bf16 v[76:79], v[168:171], v[236:239], v[76:79]
    s_waitcnt lgkmcnt(3)
    v_mfma_f32_16x16x32_bf16 v[80:83], v[172:175], v[224:227], v[80:83]
    s_add_u32 m0, s75, 14336
    s_nop 0
    buffer_load_dwordx4 v8, s[44:47], s81 offen sc1 lds
    v_mfma_f32_16x16x32_bf16 v[84:87], v[172:175], v[228:231], v[84:87]
    ds_read_b128 v[168:171], v10 offset:23552
    v_mfma_f32_16x16x32_bf16 v[88:91], v[172:175], v[232:235], v[88:91]
    v_mfma_f32_16x16x32_bf16 v[92:95], v[172:175], v[236:239], v[92:95]
    s_waitcnt vmcnt(23)
    s_waitcnt lgkmcnt(3)
    v_mfma_f32_16x16x32_bf16 v[16:19], v[156:159], v[240:243], v[16:19]
    buffer_load_dwordx4 v[224:227], v13, s[44:47], s76 offen offset:0 sc1
    v_mfma_f32_16x16x32_bf16 v[20:23], v[156:159], v[244:247], v[20:23]
    ds_read_b128 v[172:175], v10 offset:24576
    v_mfma_f32_16x16x32_bf16 v[24:27], v[156:159], v[248:251], v[24:27]
    buffer_load_dwordx4 v[228:231], v13, s[44:47], s77 offen offset:0 sc1
    v_mfma_f32_16x16x32_bf16 v[28:31], v[156:159], v[252:255], v[28:31]
    s_waitcnt lgkmcnt(3)
    v_mfma_f32_16x16x32_bf16 v[32:35], v[160:163], v[240:243], v[32:35]
    buffer_load_dwordx4 v[232:235], v13, s[44:47], s78 offen offset:0 sc1
    v_mfma_f32_16x16x32_bf16 v[36:39], v[160:163], v[244:247], v[36:39]
    ds_read_b128 v[156:159], v10 offset:25600
    v_mfma_f32_16x16x32_bf16 v[40:43], v[160:163], v[248:251], v[40:43]
    buffer_load_dwordx4 v[236:239], v13, s[44:47], s79 offen offset:0 sc1
    v_mfma_f32_16x16x32_bf16 v[44:47], v[160:163], v[252:255], v[44:47]
    s_waitcnt lgkmcnt(3)
    v_mfma_f32_16x16x32_bf16 v[48:51], v[164:167], v[240:243], v[48:51]
    v_mfma_f32_16x16x32_bf16 v[52:55], v[164:167], v[244:247], v[52:55]
    ds_read_b128 v[160:163], v10 offset:26624
    v_mfma_f32_16x16x32_bf16 v[56:59], v[164:167], v[248:251], v[56:59]
    v_mfma_f32_16x16x32_bf16 v[60:63], v[164:167], v[252:255], v[60:63]
    s_waitcnt lgkmcnt(3)
    v_mfma_f32_16x16x32_bf16 v[64:67], v[168:171], v[240:243], v[64:67]
    v_mfma_f32_16x16x32_bf16 v[68:71], v[168:171], v[244:247], v[68:71]
    ds_read_b128 v[164:167], v10 offset:27648
    v_mfma_f32_16x16x32_bf16 v[72:75], v[168:171], v[248:251], v[72:75]
    v_mfma_f32_16x16x32_bf16 v[76:79], v[168:171], v[252:255], v[76:79]
    s_waitcnt lgkmcnt(3)
    v_mfma_f32_16x16x32_bf16 v[80:83], v[172:175], v[240:243], v[80:83]
    v_mfma_f32_16x16x32_bf16 v[84:87], v[172:175], v[244:247], v[84:87]
    ds_read_b128 v[168:171], v10 offset:28672
    v_mfma_f32_16x16x32_bf16 v[88:91], v[172:175], v[248:251], v[88:91]
    v_mfma_f32_16x16x32_bf16 v[92:95], v[172:175], v[252:255], v[92:95]
    v_mov_b32 v2, 161776
    v_mov_b32 v3, 1
    ds_write_b32 v2, v3
    s_waitcnt lgkmcnt(4)
    v_mfma_f32_16x16x32_bf16 v[16:19], v[156:159], v[176:179], v[16:19]
    buffer_load_dwordx4 v[240:243], v13, s[44:47], s76 offen offset:1024 sc1
    v_mfma_f32_16x16x32_bf16 v[20:23], v[156:159], v[180:183], v[20:23]
    ds_read_b128 v[172:175], v10 offset:29696
    v_mfma_f32_16x16x32_bf16 v[24:27], v[156:159], v[184:187], v[24:27]
    buffer_load_dwordx4 v[244:247], v13, s[44:47], s77 offen offset:1024 sc1
    v_mfma_f32_16x16x32_bf16 v[28:31], v[156:159], v[188:191], v[28:31]
    s_waitcnt lgkmcnt(4)
    v_mfma_f32_16x16x32_bf16 v[32:35], v[160:163], v[176:179], v[32:35]
    buffer_load_dwordx4 v[248:251], v13, s[44:47], s78 offen offset:1024 sc1
    v_mfma_f32_16x16x32_bf16 v[36:39], v[160:163], v[180:183], v[36:39]
    v_mfma_f32_16x16x32_bf16 v[40:43], v[160:163], v[184:187], v[40:43]
    buffer_load_dwordx4 v[252:255], v13, s[44:47], s79 offen offset:1024 sc1
    v_mfma_f32_16x16x32_bf16 v[44:47], v[160:163], v[188:191], v[44:47]
    s_waitcnt lgkmcnt(3)
    v_mfma_f32_16x16x32_bf16 v[48:51], v[164:167], v[176:179], v[48:51]
    v_mfma_f32_16x16x32_bf16 v[52:55], v[164:167], v[180:183], v[52:55]
    v_mfma_f32_16x16x32_bf16 v[56:59], v[164:167], v[184:187], v[56:59]
    v_mfma_f32_16x16x32_bf16 v[60:63], v[164:167], v[188:191], v[60:63]
    s_waitcnt lgkmcnt(2)
    v_mfma_f32_16x16x32_bf16 v[64:67], v[168:171], v[176:179], v[64:67]
    v_mfma_f32_16x16x32_bf16 v[68:71], v[168:171], v[180:183], v[68:71]
    v_mfma_f32_16x16x32_bf16 v[72:75], v[168:171], v[184:187], v[72:75]
    v_mfma_f32_16x16x32_bf16 v[76:79], v[168:171], v[188:191], v[76:79]
    s_waitcnt lgkmcnt(0)
    v_mfma_f32_16x16x32_bf16 v[80:83], v[172:175], v[176:179], v[80:83]
    v_mfma_f32_16x16x32_bf16 v[84:87], v[172:175], v[180:183], v[84:87]
    v_mfma_f32_16x16x32_bf16 v[88:91], v[172:175], v[184:187], v[88:91]
    v_mfma_f32_16x16x32_bf16 v[92:95], v[172:175], v[188:191], v[92:95]
    s_waitcnt vmcnt(23)
    v_mfma_f32_16x16x32_bf16 v[16:19], v[96:99], v[192:195], v[16:19]
    buffer_load_dwordx4 v[176:179], v13, s[44:47], s76 offen offset:2048 sc1
    v_mfma_f32_16x16x32_bf16 v[20:23], v[96:99], v[196:199], v[20:23]
    v_mfma_f32_16x16x32_bf16 v[24:27], v[96:99], v[200:203], v[24:27]
    buffer_load_dwordx4 v[180:183], v13, s[44:47], s77 offen offset:2048 sc1
    v_mfma_f32_16x16x32_bf16 v[28:31], v[96:99], v[204:207], v[28:31]
    v_mfma_f32_16x16x32_bf16 v[32:35], v[100:103], v[192:195], v[32:35]
    buffer_load_dwordx4 v[184:187], v13, s[44:47], s78 offen offset:2048 sc1
    v_mfma_f32_16x16x32_bf16 v[36:39], v[100:103], v[196:199], v[36:39]
    v_mfma_f32_16x16x32_bf16 v[40:43], v[100:103], v[200:203], v[40:43]
    buffer_load_dwordx4 v[188:191], v13, s[44:47], s79 offen offset:2048 sc1
    v_mfma_f32_16x16x32_bf16 v[44:47], v[100:103], v[204:207], v[44:47]
    v_mfma_f32_16x16x32_bf16 v[48:51], v[104:107], v[192:195], v[48:51]
    v_mfma_f32_16x16x32_bf16 v[52:55], v[104:107], v[196:199], v[52:55]
    v_mfma_f32_16x16x32_bf16 v[56:59], v[104:107], v[200:203], v[56:59]
    v_mfma_f32_16x16x32_bf16 v[60:63], v[104:107], v[204:207], v[60:63]
    v_mfma_f32_16x16x32_bf16 v[64:67], v[108:111], v[192:195], v[64:67]
    v_mfma_f32_16x16x32_bf16 v[68:71], v[108:111], v[196:199], v[68:71]
    v_mfma_f32_16x16x32_bf16 v[72:75], v[108:111], v[200:203], v[72:75]
    v_mfma_f32_16x16x32_bf16 v[76:79], v[108:111], v[204:207], v[76:79]
    v_mfma_f32_16x16x32_bf16 v[80:83], v[112:115], v[192:195], v[80:83]
    v_mfma_f32_16x16x32_bf16 v[84:87], v[112:115], v[196:199], v[84:87]
    v_mfma_f32_16x16x32_bf16 v[88:91], v[112:115], v[200:203], v[88:91]
    v_mfma_f32_16x16x32_bf16 v[92:95], v[112:115], v[204:207], v[92:95]
    s_waitcnt vmcnt(17)
    v_mfma_f32_16x16x32_bf16 v[16:19], v[116:119], v[208:211], v[16:19]
    buffer_load_dwordx4 v[192:195], v13, s[44:47], s76 offen offset:3072 sc1
    v_mfma_f32_16x16x32_bf16 v[20:23], v[116:119], v[212:215], v[20:23]
    v_mfma_f32_16x16x32_bf16 v[24:27], v[116:119], v[216:219], v[24:27]
    buffer_load_dwordx4 v[196:199], v13, s[44:47], s77 offen offset:3072 sc1
    v_mfma_f32_16x16x32_bf16 v[28:31], v[116:119], v[220:223], v[28:31]
    v_mfma_f32_16x16x32_bf16 v[32:35], v[120:123], v[208:211], v[32:35]
    buffer_load_dwordx4 v[200:203], v13, s[44:47], s78 offen offset:3072 sc1
    v_mfma_f32_16x16x32_bf16 v[36:39], v[120:123], v[212:215], v[36:39]
    v_mfma_f32_16x16x32_bf16 v[40:43], v[120:123], v[216:219], v[40:43]
    buffer_load_dwordx4 v[204:207], v13, s[44:47], s79 offen offset:3072 sc1
    v_mfma_f32_16x16x32_bf16 v[44:47], v[120:123], v[220:223], v[44:47]
    v_mfma_f32_16x16x32_bf16 v[48:51], v[124:127], v[208:211], v[48:51]
    v_mfma_f32_16x16x32_bf16 v[52:55], v[124:127], v[212:215], v[52:55]
    v_mfma_f32_16x16x32_bf16 v[56:59], v[124:127], v[216:219], v[56:59]
    v_mfma_f32_16x16x32_bf16 v[60:63], v[124:127], v[220:223], v[60:63]
    v_mfma_f32_16x16x32_bf16 v[64:67], v[128:131], v[208:211], v[64:67]
    v_mfma_f32_16x16x32_bf16 v[68:71], v[128:131], v[212:215], v[68:71]
    v_mfma_f32_16x16x32_bf16 v[72:75], v[128:131], v[216:219], v[72:75]
    v_mfma_f32_16x16x32_bf16 v[76:79], v[128:131], v[220:223], v[76:79]
    v_mfma_f32_16x16x32_bf16 v[80:83], v[132:135], v[208:211], v[80:83]
    v_mfma_f32_16x16x32_bf16 v[84:87], v[132:135], v[212:215], v[84:87]
    v_mfma_f32_16x16x32_bf16 v[88:91], v[132:135], v[216:219], v[88:91]
    v_mfma_f32_16x16x32_bf16 v[92:95], v[132:135], v[220:223], v[92:95]
    s_waitcnt vmcnt(12)
    v_mfma_f32_16x16x32_bf16 v[16:19], v[136:139], v[224:227], v[16:19]
    v_mfma_f32_16x16x32_bf16 v[20:23], v[136:139], v[228:231], v[20:23]
    v_mfma_f32_16x16x32_bf16 v[24:27], v[136:139], v[232:235], v[24:27]
    v_mfma_f32_16x16x32_bf16 v[28:31], v[136:139], v[236:239], v[28:31]
    v_mfma_f32_16x16x32_bf16 v[32:35], v[140:143], v[224:227], v[32:35]
    v_mfma_f32_16x16x32_bf16 v[36:39], v[140:143], v[228:231], v[36:39]
    ds_read_b128 v[156:159], v10 offset:0
    v_mfma_f32_16x16x32_bf16 v[40:43], v[140:143], v[232:235], v[40:43]
    v_mfma_f32_16x16x32_bf16 v[44:47], v[140:143], v[236:239], v[44:47]
    v_mfma_f32_16x16x32_bf16 v[48:51], v[144:147], v[224:227], v[48:51]
    v_mfma_f32_16x16x32_bf16 v[52:55], v[144:147], v[228:231], v[52:55]
    ds_read_b128 v[160:163], v10 offset:5120
    v_mfma_f32_16x16x32_bf16 v[56:59], v[144:147], v[232:235], v[56:59]
    v_mfma_f32_16x16x32_bf16 v[60:63], v[144:147], v[236:239], v[60:63]
    v_mfma_f32_16x16x32_bf16 v[64:67], v[148:151], v[224:227], v[64:67]
    v_mfma_f32_16x16x32_bf16 v[68:71], v[148:151], v[228:231], v[68:71]
    ds_read_b128 v[164:167], v10 offset:10240
    v_mfma_f32_16x16x32_bf16 v[72:75], v[148:151], v[232:235], v[72:75]
    v_mfma_f32_16x16x32_bf16 v[76:79], v[148:151], v[236:239], v[76:79]
    v_mfma_f32_16x16x32_bf16 v[80:83], v[152:155], v[224:227], v[80:83]
    v_mfma_f32_16x16x32_bf16 v[84:87], v[152:155], v[228:231], v[84:87]
    ds_read_b128 v[168:171], v10 offset:1024
    v_mfma_f32_16x16x32_bf16 v[88:91], v[152:155], v[232:235], v[88:91]
    v_mfma_f32_16x16x32_bf16 v[92:95], v[152:155], v[236:239], v[92:95]
    s_waitcnt vmcnt(8)
    s_waitcnt lgkmcnt(3)
    v_mfma_f32_16x16x32_bf16 v[16:19], v[156:159], v[240:243], v[16:19]
    v_mfma_f32_16x16x32_bf16 v[20:23], v[156:159], v[244:247], v[20:23]
    ds_read_b128 v[172:175], v10 offset:6144
    v_mfma_f32_16x16x32_bf16 v[24:27], v[156:159], v[248:251], v[24:27]
    v_mfma_f32_16x16x32_bf16 v[28:31], v[156:159], v[252:255], v[28:31]
    s_waitcnt vmcnt(4)
    s_waitcnt lgkmcnt(3)
    v_mfma_f32_16x16x32_bf16 v[16:19], v[160:163], v[176:179], v[16:19]
    v_mfma_f32_16x16x32_bf16 v[20:23], v[160:163], v[180:183], v[20:23]
    ds_read_b128 v[156:159], v10 offset:11264
    v_mfma_f32_16x16x32_bf16 v[24:27], v[160:163], v[184:187], v[24:27]
    v_mfma_f32_16x16x32_bf16 v[28:31], v[160:163], v[188:191], v[28:31]
    s_waitcnt vmcnt(0)
    s_waitcnt lgkmcnt(3)
    v_mfma_f32_16x16x32_bf16 v[16:19], v[164:167], v[192:195], v[16:19]
    v_mfma_f32_16x16x32_bf16 v[20:23], v[164:167], v[196:199], v[20:23]
    ds_read_b128 v[160:163], v10 offset:2048
    v_mfma_f32_16x16x32_bf16 v[24:27], v[164:167], v[200:203], v[24:27]
    v_mfma_f32_16x16x32_bf16 v[28:31], v[164:167], v[204:207], v[28:31]
    s_waitcnt lgkmcnt(3)
    v_mfma_f32_16x16x32_bf16 v[32:35], v[168:171], v[240:243], v[32:35]
    v_mfma_f32_16x16x32_bf16 v[36:39], v[168:171], v[244:247], v[36:39]
    ds_read_b128 v[164:167], v10 offset:7168
    v_mfma_f32_16x16x32_bf16 v[40:43], v[168:171], v[248:251], v[40:43]
    v_mfma_f32_16x16x32_bf16 v[44:47], v[168:171], v[252:255], v[44:47]
    ds_write_b128 v10, v[20:23] offset:15360
    s_waitcnt lgkmcnt(4)
    v_mfma_f32_16x16x32_bf16 v[32:35], v[172:175], v[176:179], v[32:35]
    v_mfma_f32_16x16x32_bf16 v[36:39], v[172:175], v[180:183], v[36:39]
    ds_read_b128 v[168:171], v10 offset:12288
    v_mfma_f32_16x16x32_bf16 v[40:43], v[172:175], v[184:187], v[40:43]
    v_mfma_f32_16x16x32_bf16 v[44:47], v[172:175], v[188:191], v[44:47]
    ds_write_b128 v10, v[24:27] offset:20480
    s_waitcnt lgkmcnt(5)
    v_mfma_f32_16x16x32_bf16 v[32:35], v[156:159], v[192:195], v[32:35]
    v_mfma_f32_16x16x32_bf16 v[36:39], v[156:159], v[196:199], v[36:39]
    ds_read_b128 v[172:175], v10 offset:3072
    v_mfma_f32_16x16x32_bf16 v[40:43], v[156:159], v[200:203], v[40:43]
    v_mfma_f32_16x16x32_bf16 v[44:47], v[156:159], v[204:207], v[44:47]
    ds_write_b128 v10, v[28:31] offset:25600
    s_waitcnt lgkmcnt(6)
    v_mfma_f32_16x16x32_bf16 v[48:51], v[160:163], v[240:243], v[48:51]
    v_mfma_f32_16x16x32_bf16 v[52:55], v[160:163], v[244:247], v[52:55]
    ds_read_b128 v[156:159], v10 offset:8192
    v_mfma_f32_16x16x32_bf16 v[56:59], v[160:163], v[248:251], v[56:59]
    v_mfma_f32_16x16x32_bf16 v[60:63], v[160:163], v[252:255], v[60:63]
    ds_write_b128 v10, v[36:39] offset:16384
    s_waitcnt lgkmcnt(7)
    v_mfma_f32_16x16x32_bf16 v[48:51], v[164:167], v[176:179], v[48:51]
    v_mfma_f32_16x16x32_bf16 v[52:55], v[164:167], v[180:183], v[52:55]
    ds_read_b128 v[160:163], v10 offset:13312
    v_mfma_f32_16x16x32_bf16 v[56:59], v[164:167], v[184:187], v[56:59]
    v_mfma_f32_16x16x32_bf16 v[60:63], v[164:167], v[188:191], v[60:63]
    ds_write_b128 v10, v[40:43] offset:21504
    s_waitcnt lgkmcnt(7)
    v_mfma_f32_16x16x32_bf16 v[48:51], v[168:171], v[192:195], v[48:51]
    v_mfma_f32_16x16x32_bf16 v[52:55], v[168:171], v[196:199], v[52:55]
    ds_read_b128 v[164:167], v10 offset:4096
    v_mfma_f32_16x16x32_bf16 v[56:59], v[168:171], v[200:203], v[56:59]
    v_mfma_f32_16x16x32_bf16 v[60:63], v[168:171], v[204:207], v[60:63]
    ds_write_b128 v10, v[44:47] offset:26624
    s_waitcnt lgkmcnt(7)
    v_mfma_f32_16x16x32_bf16 v[64:67], v[172:175], v[240:243], v[64:67]
    v_mfma_f32_16x16x32_bf16 v[68:71], v[172:175], v[244:247], v[68:71]
    ds_read_b128 v[168:171], v10 offset:9216
    v_mfma_f32_16x16x32_bf16 v[72:75], v[172:175], v[248:251], v[72:75]
    v_mfma_f32_16x16x32_bf16 v[76:79], v[172:175], v[252:255], v[76:79]
    ds_write_b128 v10, v[52:55] offset:17408
    s_waitcnt lgkmcnt(7)
    v_mfma_f32_16x16x32_bf16 v[64:67], v[156:159], v[176:179], v[64:67]
    v_mfma_f32_16x16x32_bf16 v[68:71], v[156:159], v[180:183], v[68:71]
    ds_read_b128 v[172:175], v10 offset:14336
    v_mfma_f32_16x16x32_bf16 v[72:75], v[156:159], v[184:187], v[72:75]
    v_mfma_f32_16x16x32_bf16 v[76:79], v[156:159], v[188:191], v[76:79]
    ds_write_b128 v10, v[56:59] offset:22528
    s_waitcnt lgkmcnt(7)
    v_mfma_f32_16x16x32_bf16 v[64:67], v[160:163], v[192:195], v[64:67]
    v_mfma_f32_16x16x32_bf16 v[68:71], v[160:163], v[196:199], v[68:71]
    v_mfma_f32_16x16x32_bf16 v[72:75], v[160:163], v[200:203], v[72:75]
    v_mfma_f32_16x16x32_bf16 v[76:79], v[160:163], v[204:207], v[76:79]
    ds_write_b128 v10, v[60:63] offset:27648
    s_waitcnt lgkmcnt(6)
    v_mfma_f32_16x16x32_bf16 v[80:83], v[164:167], v[240:243], v[80:83]
    v_mfma_f32_16x16x32_bf16 v[84:87], v[164:167], v[244:247], v[84:87]
    v_mfma_f32_16x16x32_bf16 v[88:91], v[164:167], v[248:251], v[88:91]
    v_mfma_f32_16x16x32_bf16 v[92:95], v[164:167], v[252:255], v[92:95]
    ds_write_b128 v10, v[68:71] offset:18432
    s_waitcnt lgkmcnt(5)
    v_mfma_f32_16x16x32_bf16 v[80:83], v[168:171], v[176:179], v[80:83]
    v_mfma_f32_16x16x32_bf16 v[84:87], v[168:171], v[180:183], v[84:87]
    v_mfma_f32_16x16x32_bf16 v[88:91], v[168:171], v[184:187], v[88:91]
    v_mfma_f32_16x16x32_bf16 v[92:95], v[168:171], v[188:191], v[92:95]
    ds_write_b128 v10, v[72:75] offset:23552
    s_waitcnt lgkmcnt(4)
    v_mfma_f32_16x16x32_bf16 v[80:83], v[172:175], v[192:195], v[80:83]
    v_mfma_f32_16x16x32_bf16 v[84:87], v[172:175], v[196:199], v[84:87]
    v_mfma_f32_16x16x32_bf16 v[88:91], v[172:175], v[200:203], v[88:91]
    v_mfma_f32_16x16x32_bf16 v[92:95], v[172:175], v[204:207], v[92:95]
    ds_write_b128 v10, v[76:79] offset:28672
    s_nop 4
    ds_write_b128 v10, v[84:87] offset:19456
    ds_write_b128 v10, v[88:91] offset:24576
    ds_write_b128 v10, v[92:95] offset:29696
    s_setprio 2
    s_mov_b32 s56, s28
    s_and_b32 s57, s29, 0xffff
    s_mov_b32 s58, 2621440
    s_mov_b32 s59, 0x00020000
    s_sub_u32 s60, s34, 1
    s_and_b32 s60, s60, 3
    s_mul_i32 s60, s60, 30720
    s_add_u32 s60, s60, 15360
    v_add_u32 v5, s60, v9
    s_sub_u32 s60, s34, 2
    s_and_b32 s60, s60, 3
    s_mul_i32 s60, s60, 30720
    s_add_u32 s60, s60, 20480
    v_add_u32 v6, s60, v9
    s_sub_u32 s60, s34, 3
    s_and_b32 s60, s60, 3
    s_mul_i32 s60, s60, 30720
    s_add_u32 s60, s60, 25600
    v_add_u32 v7, s60, v9
    v_and_b32 v2, 15, v0
    v_lshrrev_b32 v3, 4, v0
    v_lshrrev_b32 v12, 2, v2
    v_lshl_add_u32 v12, v3, 2, v12
    v_lshlrev_b32 v12, 7, v12
    v_and_b32 v15, 3, v0
    v_lshl_add_u32 v12, v15, 3, v12
    s_lshl_b32 s60, s34, 5
    s_add_u32 s60, s60, 122880
    v_add_u32 v12, s60, v12
    s_mul_i32 s60, s34, 2816
    s_add_u32 s60, s60, 135776
    v_mul_u32_u24 v11, 176, v2
    v_lshl_add_u32 v11, v3, 3, v11
    v_add_u32 v11, s60, v11
    v_lshlrev_b32 v13, 4, v3
    v_add_u32 v13, 162080, v13
    v_mov_b32 v250, 1.0
    v_mov_b32 v251, 1.0
    v_mov_b32 v252, 0xbfb8aa3b
    s_lshl_b32 s80, s39, 2
    s_add_u32 s80, s80, s34
    s_mul_i32 s80, s80, 20480
    s_mul_i32 s61, s40, 160
    s_add_u32 s80, s80, s61
    v_add_u32 v2, 0, v0
    v_mul_u32_u24 v3, 52429, v2
    v_lshrrev_b32 v3, 19, v3
    v_mul_u32_u24 v4, 10, v3
    v_sub_u32 v4, v2, v4
    v_lshlrev_b32 v4, 4, v4
    v_mul_u32_u24 v2, 176, v3
    v_add3_u32 v240, v2, v4, s60
    v_mul_u32_u24 v3, 1280, v3
    v_add_u32 v243, v3, v4
    v_add_u32 v2, 64, v0
    v_mul_u32_u24 v3, 52429, v2
    v_lshrrev_b32 v3, 19, v3
    v_mul_u32_u24 v4, 10, v3
    v_sub_u32 v4, v2, v4
    v_lshlrev_b32 v4, 4, v4
    v_mul_u32_u24 v2, 176, v3
    v_add3_u32 v241, v2, v4, s60
    v_mul_u32_u24 v3, 1280, v3
    v_add_u32 v244, v3, v4
    v_add_u32 v2, 128, v0
    v_mul_u32_u24 v3, 52429, v2
    v_lshrrev_b32 v3, 19, v3
    v_mul_u32_u24 v4, 10, v3
    v_sub_u32 v4, v2, v4
    v_lshlrev_b32 v4, 4, v4
    v_mul_u32_u24 v2, 176, v3
    v_add3_u32 v242, v2, v4, s60
    v_mul_u32_u24 v3, 1280, v3
    v_add_u32 v245, v3, v4
    s_waitcnt lgkmcnt(0)
    s_barrier
    ds_read_b128 v[96:99], v5 offset:0
    ds_read_b128 v[100:103], v6 offset:0
    ds_read_b128 v[104:107], v7 offset:0
    ds_read_b128 v[108:111], v13 offset:0
    ds_read_b64_tr_b16 v[112:113], v12 offset:0
    ds_read_b64 v[114:115], v11 offset:0
    ds_read_b128 v[116:119], v5 offset:1024
    ds_read_b128 v[120:123], v6 offset:1024
    ds_read_b128 v[124:127], v7 offset:1024
    ds_read_b128 v[128:131], v13 offset:64
    ds_read_b64_tr_b16 v[132:133], v12 offset:2048
    ds_read_b64 v[134:135], v11 offset:32
    s_waitcnt lgkmcnt(6)
    v_pk_add_f32 v[16:17], v[16:17], v[96:97]
    v_pk_add_f32 v[18:19], v[18:19], v[98:99]
    v_pk_add_f32 v[100:101], v[100:101], v[104:105]
    v_pk_add_f32 v[102:103], v[102:103], v[106:107]
    v_pk_add_f32 v[16:17], v[16:17], v[108:109]
    v_pk_add_f32 v[18:19], v[18:19], v[110:111]
    v_pk_add_f32 v[16:17], v[16:17], v[100:101]
    v_pk_add_f32 v[18:19], v[18:19], v[102:103]
    v_pk_mul_f32 v[200:201], v[16:17], v[252:253] op_sel_hi:[1,0]
    v_pk_mul_f32 v[202:203], v[18:19], v[252:253] op_sel_hi:[1,0]
    v_exp_f32 v200, v200
    v_exp_f32 v201, v201
    v_exp_f32 v202, v202
    v_exp_f32 v203, v203
    ds_read_b128 v[136:139], v5 offset:2048
    ds_read_b128 v[140:143], v6 offset:2048
    ds_read_b128 v[144:147], v7 offset:2048
    ds_read_b128 v[148:151], v13 offset:128
    ds_read_b64_tr_b16 v[152:153], v12 offset:4096
    ds_read_b64 v[154:155], v11 offset:64
    v_lshlrev_b32 v204, 16, v112
    v_and_b32 v205, 0xffff0000, v112
    v_lshlrev_b32 v206, 16, v113
    v_and_b32 v207, 0xffff0000, v113
    v_pk_add_f32 v[200:201], v[200:201], v[250:251]
    v_pk_add_f32 v[202:203], v[202:203], v[250:251]
    v_rcp_f32 v200, v200
    v_rcp_f32 v201, v201
    v_rcp_f32 v202, v202
    v_rcp_f32 v203, v203
    v_pk_mul_f32 v[204:205], v[204:205], v[16:17]
    v_pk_mul_f32 v[206:207], v[206:207], v[18:19]
    v_lshlrev_b32 v208, 16, v114
    v_and_b32 v209, 0xffff0000, v114
    v_lshlrev_b32 v210, 16, v115
    v_and_b32 v211, 0xffff0000, v115
    v_pk_fma_f32 v[208:209], v[204:205], v[200:201], v[208:209]
    v_pk_fma_f32 v[210:211], v[206:207], v[202:203], v[210:211]
    v_cvt_pk_bf16_f32 v114, v208, v209
    v_cvt_pk_bf16_f32 v115, v210, v211
    ds_write_b64 v11, v[114:115] offset:0
    s_waitcnt lgkmcnt(6)
    v_pk_add_f32 v[32:33], v[32:33], v[116:117]
    v_pk_add_f32 v[34:35], v[34:35], v[118:119]
    v_pk_add_f32 v[120:121], v[120:121], v[124:125]
    v_pk_add_f32 v[122:123], v[122:123], v[126:127]
    v_pk_add_f32 v[32:33], v[32:33], v[128:129]
    v_pk_add_f32 v[34:35], v[34:35], v[130:131]
    v_pk_add_f32 v[32:33], v[32:33], v[120:121]
    v_pk_add_f32 v[34:35], v[34:35], v[122:123]
    v_pk_mul_f32 v[212:213], v[32:33], v[252:253] op_sel_hi:[1,0]
    v_pk_mul_f32 v[214:215], v[34:35], v[252:253] op_sel_hi:[1,0]
    v_exp_f32 v212, v212
    v_exp_f32 v213, v213
    v_exp_f32 v214, v214
    v_exp_f32 v215, v215
    ds_read_b128 v[156:159], v5 offset:3072
    ds_read_b128 v[160:163], v6 offset:3072
    ds_read_b128 v[164:167], v7 offset:3072
    ds_read_b128 v[168:171], v13 offset:192
    ds_read_b64_tr_b16 v[172:173], v12 offset:6144
    ds_read_b64 v[174:175], v11 offset:96
    v_lshlrev_b32 v216, 16, v132
    v_and_b32 v217, 0xffff0000, v132
    v_lshlrev_b32 v218, 16, v133
    v_and_b32 v219, 0xffff0000, v133
    v_pk_add_f32 v[212:213], v[212:213], v[250:251]
    v_pk_add_f32 v[214:215], v[214:215], v[250:251]
    v_rcp_f32 v212, v212
    v_rcp_f32 v213, v213
    v_rcp_f32 v214, v214
    v_rcp_f32 v215, v215
    v_pk_mul_f32 v[216:217], v[216:217], v[32:33]
    v_pk_mul_f32 v[218:219], v[218:219], v[34:35]
    v_lshlrev_b32 v220, 16, v134
    v_and_b32 v221, 0xffff0000, v134
    v_lshlrev_b32 v222, 16, v135
    v_and_b32 v223, 0xffff0000, v135
    v_pk_fma_f32 v[220:221], v[216:217], v[212:213], v[220:221]
    v_pk_fma_f32 v[222:223], v[218:219], v[214:215], v[222:223]
    v_cvt_pk_bf16_f32 v134, v220, v221
    v_cvt_pk_bf16_f32 v135, v222, v223
    ds_write_b64 v11, v[134:135] offset:32
    s_waitcnt lgkmcnt(6)
    v_pk_add_f32 v[48:49], v[48:49], v[136:137]
    v_pk_add_f32 v[50:51], v[50:51], v[138:139]
    v_pk_add_f32 v[140:141], v[140:141], v[144:145]
    v_pk_add_f32 v[142:143], v[142:143], v[146:147]
    v_pk_add_f32 v[48:49], v[48:49], v[148:149]
    v_pk_add_f32 v[50:51], v[50:51], v[150:151]
    v_pk_add_f32 v[48:49], v[48:49], v[140:141]
    v_pk_add_f32 v[50:51], v[50:51], v[142:143]
    v_pk_mul_f32 v[200:201], v[48:49], v[252:253] op_sel_hi:[1,0]
    v_pk_mul_f32 v[202:203], v[50:51], v[252:253] op_sel_hi:[1,0]
    v_exp_f32 v200, v200
    v_exp_f32 v201, v201
    v_exp_f32 v202, v202
    v_exp_f32 v203, v203
    ds_read_b128 v[176:179], v5 offset:4096
    ds_read_b128 v[180:183], v6 offset:4096
    ds_read_b128 v[184:187], v7 offset:4096
    ds_read_b128 v[188:191], v13 offset:256
    ds_read_b64_tr_b16 v[192:193], v12 offset:8192
    ds_read_b64 v[194:195], v11 offset:128
    v_lshlrev_b32 v204, 16, v152
    v_and_b32 v205, 0xffff0000, v152
    v_lshlrev_b32 v206, 16, v153
    v_and_b32 v207, 0xffff0000, v153
    v_pk_add_f32 v[200:201], v[200:201], v[250:251]
    v_pk_add_f32 v[202:203], v[202:203], v[250:251]
    v_rcp_f32 v200, v200
    v_rcp_f32 v201, v201
    v_rcp_f32 v202, v202
    v_rcp_f32 v203, v203
    v_pk_mul_f32 v[204:205], v[204:205], v[48:49]
    v_pk_mul_f32 v[206:207], v[206:207], v[50:51]
    v_lshlrev_b32 v208, 16, v154
    v_and_b32 v209, 0xffff0000, v154
    v_lshlrev_b32 v210, 16, v155
    v_and_b32 v211, 0xffff0000, v155
    v_pk_fma_f32 v[208:209], v[204:205], v[200:201], v[208:209]
    v_pk_fma_f32 v[210:211], v[206:207], v[202:203], v[210:211]
    v_cvt_pk_bf16_f32 v154, v208, v209
    v_cvt_pk_bf16_f32 v155, v210, v211
    ds_write_b64 v11, v[154:155] offset:64
    s_waitcnt lgkmcnt(6)
    v_pk_add_f32 v[64:65], v[64:65], v[156:157]
    v_pk_add_f32 v[66:67], v[66:67], v[158:159]
    v_pk_add_f32 v[160:161], v[160:161], v[164:165]
    v_pk_add_f32 v[162:163], v[162:163], v[166:167]
    v_pk_add_f32 v[64:65], v[64:65], v[168:169]
    v_pk_add_f32 v[66:67], v[66:67], v[170:171]
    v_pk_add_f32 v[64:65], v[64:65], v[160:161]
    v_pk_add_f32 v[66:67], v[66:67], v[162:163]
    v_pk_mul_f32 v[212:213], v[64:65], v[252:253] op_sel_hi:[1,0]
    v_pk_mul_f32 v[214:215], v[66:67], v[252:253] op_sel_hi:[1,0]
    v_exp_f32 v212, v212
    v_exp_f32 v213, v213
    v_exp_f32 v214, v214
    v_exp_f32 v215, v215
    v_lshlrev_b32 v216, 16, v172
    v_and_b32 v217, 0xffff0000, v172
    v_lshlrev_b32 v218, 16, v173
    v_and_b32 v219, 0xffff0000, v173
    v_pk_add_f32 v[212:213], v[212:213], v[250:251]
    v_pk_add_f32 v[214:215], v[214:215], v[250:251]
    v_rcp_f32 v212, v212
    v_rcp_f32 v213, v213
    v_rcp_f32 v214, v214
    v_rcp_f32 v215, v215
    v_pk_mul_f32 v[216:217], v[216:217], v[64:65]
    v_pk_mul_f32 v[218:219], v[218:219], v[66:67]
    v_lshlrev_b32 v220, 16, v174
    v_and_b32 v221, 0xffff0000, v174
    v_lshlrev_b32 v222, 16, v175
    v_and_b32 v223, 0xffff0000, v175
    v_pk_fma_f32 v[220:221], v[216:217], v[212:213], v[220:221]
    v_pk_fma_f32 v[222:223], v[218:219], v[214:215], v[222:223]
    v_cvt_pk_bf16_f32 v174, v220, v221
    v_cvt_pk_bf16_f32 v175, v222, v223
    ds_write_b64 v11, v[174:175] offset:96
    s_waitcnt lgkmcnt(1)
    v_pk_add_f32 v[80:81], v[80:81], v[176:177]
    v_pk_add_f32 v[82:83], v[82:83], v[178:179]
    v_pk_add_f32 v[180:181], v[180:181], v[184:185]
    v_pk_add_f32 v[182:183], v[182:183], v[186:187]
    v_pk_add_f32 v[80:81], v[80:81], v[188:189]
    v_pk_add_f32 v[82:83], v[82:83], v[190:191]
    v_pk_add_f32 v[80:81], v[80:81], v[180:181]
    v_pk_add_f32 v[82:83], v[82:83], v[182:183]
    v_pk_mul_f32 v[200:201], v[80:81], v[252:253] op_sel_hi:[1,0]
    v_pk_mul_f32 v[202:203], v[82:83], v[252:253] op_sel_hi:[1,0]
    v_exp_f32 v200, v200
    v_exp_f32 v201, v201
    v_exp_f32 v202, v202
    v_exp_f32 v203, v203
    v_lshlrev_b32 v204, 16, v192
    v_and_b32 v205, 0xffff0000, v192
    v_lshlrev_b32 v206, 16, v193
    v_and_b32 v207, 0xffff0000, v193
    v_pk_add_f32 v[200:201], v[200:201], v[250:251]
    v_pk_add_f32 v[202:203], v[202:203], v[250:251]
    v_rcp_f32 v200, v200
    v_rcp_f32 v201, v201
    v_rcp_f32 v202, v202
    v_rcp_f32 v203, v203
    v_pk_mul_f32 v[204:205], v[204:205], v[80:81]
    v_pk_mul_f32 v[206:207], v[206:207], v[82:83]
    v_lshlrev_b32 v208, 16, v194
    v_and_b32 v209, 0xffff0000, v194
    v_lshlrev_b32 v210, 16, v195
    v_and_b32 v211, 0xffff0000, v195
    v_pk_fma_f32 v[208:209], v[204:205], v[200:201], v[208:209]
    v_pk_fma_f32 v[210:211], v[206:207], v[202:203], v[210:211]
    v_cvt_pk_bf16_f32 v194, v208, v209
    v_cvt_pk_bf16_f32 v195, v210, v211
    ds_write_b64 v11, v[194:195] offset:128
    ds_read_b128 v[224:227], v240
    ds_read_b128 v[228:231], v241
    s_mov_b32 exec_hi, 0
    ds_read_b128 v[232:235], v242
    s_mov_b64 exec, -1
    s_waitcnt lgkmcnt(1)
    buffer_store_dwordx4 v[224:227], v243, s[56:59], s80 offen sc1
    s_waitcnt lgkmcnt(0)
    buffer_store_dwordx4 v[228:231], v244, s[56:59], s80 offen sc1
    s_mov_b32 exec_hi, 0
    s_nop 2
    buffer_store_dwordx4 v[232:235], v245, s[56:59], s80 offen sc1
    s_mov_b64 exec, -1
    s_endpgm
fused_kg:
    s_mul_i32 s72, s70, 12896
    s_add_u32 s72, s72, 122880
    v_and_b32 v2, 15, v0
    v_lshrrev_b32 v3, 4, v0
    v_lshlrev_b32 v4, 3, v2
    v_lshlrev_b32 v5, 2, v3
    v_add_u32 v5, 512, v5
    v_lshlrev_b32 v6, 9, v3
    v_cmp_gt_u32 vcc, 2, v3
    s_nop 1
    v_cndmask_b32 v5, v6, v5, vcc
    v_add_u32 v5, v5, v4
    v_cndmask_b32 v6, 4, 2, vcc
    v_and_b32 v7, 1, v2
    v_cndmask_b32 v7, v7, v3, vcc
    v_cndmask_b32 v8, 8, 0, vcc
    s_add_u32 s60, s72, 32
    v_sub_u32 v9, v5, v6
    v_lshl_add_u32 v12, v9, 1, s60
    v_add_u32 v13, v12, v8
    v_add_u32 v9, v5, v6
    v_sub_u32 v9, v9, v7
    v_lshl_add_u32 v14, v9, 1, s60
    v_sub_u32 v9, v5, v6
    v_add_u32 v9, v9, v7
    v_lshl_add_u32 v15, v9, 1, s60
    v_add_u32 v15, 4158, v15
    v_cmp_eq_u32 vcc, 32, v0
    v_add_u32 v9, 4, v15
    s_nop 0
    v_cndmask_b32 v16, v15, v9, vcc
    v_add_u32 v17, 4160, v12
    v_add_u32 v18, 4160, v13
    v_lshlrev_b32 v5, 8, v3
    v_add3_u32 v5, v5, v4, v4
    v_add_u32 v5, s60, v5
    v_add_u32 v30, 512, v5
    v_add_u32 v31, 4156, v30
    v_add_u32 v32, -2, v30
    s_add_u32 s61, s60, 4088
    v_mov_b32 v33, s61
    v_add_u32 v34, 4158, v33
    v_add_u32 v35, 4160, v33
    v_and_b32 v5, 1, v3
    v_lshlrev_b32 v5, 3, v5
    v_lshrrev_b32 v6, 1, v3
    v_lshl_add_u32 v5, v6, 8, v5
    v_add3_u32 v5, v5, v4, v4
    v_add_u32 v36, s60, v5
    v_add_u32 v37, 4158, v36
    v_lshlrev_b32 v7, 3, v0
    v_add_u32 v38, s72, v7
    v_mov_b32 v40, 0
    v_mov_b32 v41, 0
    v_lshlrev_b32 v4, 3, v3
    v_sub_u32 v4, v2, v4
    v_add_u32 v4, 25, v4
    v_and_b32 v5, 1, v2
    v_and_b32 v4, -2, v4
    v_lshlrev_b32 v4, 1, v4
    v_cmp_eq_u32 vcc, 0, v5
    v_mov_b32 v6, 4160
    s_nop 0
    v_cndmask_b32 v5, 0, v6, vcc
    v_add3_u32 v220, v4, v5, s72
    v_add_u32 v221, 1024, v220
    v_add_u32 v222, 2048, v220
    v_add_u32 v223, 3072, v220
    v_lshlrev_b32 v4, 5, v2
    v_lshl_add_u32 v225, v3, 3, v4
    v_lshl_add_u32 v4, v3, 4, v4
    s_add_u32 s60, s72, 8320
    v_add_u32 v224, s60, v4
    v_lshrrev_b32 v2, 2, v0
    v_mul_u32_u24 v2, 272, v2
    v_and_b32 v3, 3, v0
    v_lshl_add_u32 v2, v3, 2, v2
    v_add_u32 v10, s72, v2
    v_add_u32 v9, 4352, v10
    v_lshrrev_b32 v2, 4, v0
    v_mul_u32_u24 v2, 272, v2
    v_and_b32 v3, 15, v0
    v_lshl_add_u32 v2, v3, 4, v2
    v_add_u32 v11, s72, v2
    s_bitcmp1_b32 s71, 0
    s_cselect_b32 s60, 0, 16
    s_waitcnt lgkmcnt(0)
    s_lshl_b32 s74, s74, s60
    s_lshl_b32 s75, s75, s60
    s_and_b32 s74, s74, 0xffff0000
    s_and_b32 s75, s75, 0xffff0000
    v_mov_b32 v56, 1069066811
    v_mul_f32 v56, s74, v56
    v_exp_f32 v56, v56
    v_mov_b32 v57, s75
    v_cvt_pk_bf16_f32 v56, v56, v56
    v_and_b32 v56, 0xffff0000, v56
    v_add_f32 v58, v56, v56
    v_mov_b32 v59, 0x3f80
    s_waitcnt vmcnt(4)
    s_setprio 0
    v_lshlrev_b32 v2, 16, v44
    v_mul_f32 v2, 1069066811, v2
    v_exp_f32 v2, v2
    v_lshlrev_b32 v3, 16, v45
    v_lshlrev_b32 v66, 16, v46
    v_cvt_pk_bf16_f32 v2, v2, v2
    v_lshlrev_b32 v67, 16, v47
    v_and_b32 v2, 0xffff0000, v2
    v_mul_f32 v3, v3, v56
    v_mul_f32 v2, v2, v56
    v_mul_f32 v66, v66, v58
    v_mul_f32 v67, v67, v58
    v_mul_f32 v3, 1042479491, v3
    v_mul_f32 v2, 0xbfb8aa3b, v2
    v_mul_f32 v4, 0x41000000, v2
    v_mul_f32 v5, 0x41000000, v3
    v_mul_f32 v6, 0x43000000, v2
    v_mul_f32 v7, 0x43000000, v3
    v_fract_f32 v3, v3
    v_fract_f32 v5, v5
    v_fract_f32 v7, v7
    v_exp_f32 v2, v2
    v_exp_f32 v4, v4
    v_exp_f32 v6, v6
    v_cos_f32 v60, v3
    v_sin_f32 v61, v3
    v_cos_f32 v62, v5
    v_sin_f32 v63, v5
    v_cos_f32 v64, v7
    v_sin_f32 v65, v7
    v_mul_f32 v60, v60, v2
    v_mul_f32 v61, v61, v2
    v_mul_f32 v62, v62, v4
    v_mul_f32 v63, v63, v4
    v_mul_f32 v64, v64, v6
    v_mul_f32 v65, v65, v6
    v_cvt_pk_bf16_f32 v102, v62, v63
    v_cvt_pk_bf16_f32 v106, v66, -v67
    ds_write2_b32 v10, v59, v102 offset0:0 offset1:4
    v_pk_mul_f32 v[68:69], v[66:67], v[60:61] op_sel:[0,0] op_sel_hi:[0,1]
    v_pk_mul_f32 v[98:99], v[62:63], v[62:63] op_sel:[0,0] op_sel_hi:[0,1]
    v_pk_fma_f32 v[68:69], v[66:67], v[60:61], v[68:69] op_sel:[1,1,0] op_sel_hi:[1,0,1] neg_lo:[0,1,0]
    v_pk_fma_f32 v[98:99], v[62:63], v[62:63], v[98:99] op_sel:[1,1,0] op_sel_hi:[1,0,1] neg_lo:[0,1,0]
    v_cvt_pk_bf16_f32 v107, v68, -v69
    v_cvt_pk_bf16_f32 v103, v98, v99
    ds_write2_b32 v9, v106, v107 offset0:0 offset1:4
    v_pk_mul_f32 v[100:101], v[98:99], v[62:63] op_sel:[0,0] op_sel_hi:[0,1]
    v_pk_mul_f32 v[70:71], v[68:69], v[60:61] op_sel:[0,0] op_sel_hi:[0,1]
    v_pk_fma_f32 v[100:101], v[98:99], v[62:63], v[100:101] op_sel:[1,1,0] op_sel_hi:[1,0,1] neg_lo:[0,1,0]
    v_pk_fma_f32 v[70:71], v[68:69], v[60:61], v[70:71] op_sel:[1,1,0] op_sel_hi:[1,0,1] neg_lo:[0,1,0]
    v_cvt_pk_bf16_f32 v104, v100, v101
    v_cvt_pk_bf16_f32 v108, v70, -v71
    ds_write2_b32 v10, v103, v104 offset0:8 offset1:12
    v_pk_mul_f32 v[72:73], v[70:71], v[60:61] op_sel:[0,0] op_sel_hi:[0,1]
    v_pk_mul_f32 v[98:99], v[100:101], v[62:63] op_sel:[0,0] op_sel_hi:[0,1]
    v_pk_fma_f32 v[72:73], v[70:71], v[60:61], v[72:73] op_sel:[1,1,0] op_sel_hi:[1,0,1] neg_lo:[0,1,0]
    v_pk_fma_f32 v[98:99], v[100:101], v[62:63], v[98:99] op_sel:[1,1,0] op_sel_hi:[1,0,1] neg_lo:[0,1,0]
    v_cvt_pk_bf16_f32 v109, v72, -v73
    v_cvt_pk_bf16_f32 v105, v98, v99
    ds_write2_b32 v9, v108, v109 offset0:8 offset1:12
    v_pk_mul_f32 v[100:101], v[98:99], v[62:63] op_sel:[0,0] op_sel_hi:[0,1]
    v_pk_mul_f32 v[74:75], v[72:73], v[60:61] op_sel:[0,0] op_sel_hi:[0,1]
    v_pk_fma_f32 v[100:101], v[98:99], v[62:63], v[100:101] op_sel:[1,1,0] op_sel_hi:[1,0,1] neg_lo:[0,1,0]
    v_pk_fma_f32 v[74:75], v[72:73], v[60:61], v[74:75] op_sel:[1,1,0] op_sel_hi:[1,0,1] neg_lo:[0,1,0]
    v_cvt_pk_bf16_f32 v102, v100, v101
    v_cvt_pk_bf16_f32 v106, v74, -v75
    ds_write2_b32 v10, v105, v102 offset0:16 offset1:20
    v_pk_mul_f32 v[76:77], v[74:75], v[60:61] op_sel:[0,0] op_sel_hi:[0,1]
    v_pk_mul_f32 v[98:99], v[100:101], v[62:63] op_sel:[0,0] op_sel_hi:[0,1]
    v_pk_fma_f32 v[76:77], v[74:75], v[60:61], v[76:77] op_sel:[1,1,0] op_sel_hi:[1,0,1] neg_lo:[0,1,0]
    v_pk_fma_f32 v[98:99], v[100:101], v[62:63], v[98:99] op_sel:[1,1,0] op_sel_hi:[1,0,1] neg_lo:[0,1,0]
    v_cvt_pk_bf16_f32 v107, v76, -v77
    v_cvt_pk_bf16_f32 v103, v98, v99
    ds_write2_b32 v9, v106, v107 offset0:16 offset1:20
    v_pk_mul_f32 v[100:101], v[98:99], v[62:63] op_sel:[0,0] op_sel_hi:[0,1]
    v_pk_mul_f32 v[78:79], v[76:77], v[60:61] op_sel:[0,0] op_sel_hi:[0,1]
    v_pk_fma_f32 v[100:101], v[98:99], v[62:63], v[100:101] op_sel:[1,1,0] op_sel_hi:[1,0,1] neg_lo:[0,1,0]
    v_pk_fma_f32 v[78:79], v[76:77], v[60:61], v[78:79] op_sel:[1,1,0] op_sel_hi:[1,0,1] neg_lo:[0,1,0]
    v_cvt_pk_bf16_f32 v104, v100, v101
    v_cvt_pk_bf16_f32 v108, v78, -v79
    ds_write2_b32 v10, v103, v104 offset0:24 offset1:28
    v_pk_mul_f32 v[80:81], v[78:79], v[60:61] op_sel:[0,0] op_sel_hi:[0,1]
    v_pk_mul_f32 v[98:99], v[100:101], v[62:63] op_sel:[0,0] op_sel_hi:[0,1]
    v_pk_fma_f32 v[80:81], v[78:79], v[60:61], v[80:81] op_sel:[1,1,0] op_sel_hi:[1,0,1] neg_lo:[0,1,0]
    v_pk_fma_f32 v[98:99], v[100:101], v[62:63], v[98:99] op_sel:[1,1,0] op_sel_hi:[1,0,1] neg_lo:[0,1,0]
    v_cvt_pk_bf16_f32 v109, v80, -v81
    v_cvt_pk_bf16_f32 v105, v98, v99
    ds_write2_b32 v9, v108, v109 offset0:24 offset1:28
    v_pk_mul_f32 v[100:101], v[98:99], v[62:63] op_sel:[0,0] op_sel_hi:[0,1]
    v_pk_mul_f32 v[82:83], v[66:67], v[64:65] op_sel:[0,0] op_sel_hi:[0,1]
    v_pk_fma_f32 v[100:101], v[98:99], v[62:63], v[100:101] op_sel:[1,1,0] op_sel_hi:[1,0,1] neg_lo:[0,1,0]
    v_pk_fma_f32 v[82:83], v[66:67], v[64:65], v[82:83] op_sel:[1,1,0] op_sel_hi:[1,0,1] neg_lo:[0,1,0]
    v_cvt_pk_bf16_f32 v102, v100, v101
    v_cvt_pk_bf16_f32 v106, v82, -v83
    ds_write2_b32 v10, v105, v102 offset0:32 offset1:36
    v_pk_mul_f32 v[84:85], v[68:69], v[64:65] op_sel:[0,0] op_sel_hi:[0,1]
    v_pk_mul_f32 v[98:99], v[100:101], v[62:63] op_sel:[0,0] op_sel_hi:[0,1]
    v_pk_fma_f32 v[84:85], v[68:69], v[64:65], v[84:85] op_sel:[1,1,0] op_sel_hi:[1,0,1] neg_lo:[0,1,0]
    v_pk_fma_f32 v[98:99], v[100:101], v[62:63], v[98:99] op_sel:[1,1,0] op_sel_hi:[1,0,1] neg_lo:[0,1,0]
    v_cvt_pk_bf16_f32 v107, v84, -v85
    v_cvt_pk_bf16_f32 v103, v98, v99
    ds_write2_b32 v9, v106, v107 offset0:32 offset1:36
    v_pk_mul_f32 v[100:101], v[98:99], v[62:63] op_sel:[0,0] op_sel_hi:[0,1]
    v_pk_mul_f32 v[86:87], v[70:71], v[64:65] op_sel:[0,0] op_sel_hi:[0,1]
    v_pk_fma_f32 v[100:101], v[98:99], v[62:63], v[100:101] op_sel:[1,1,0] op_sel_hi:[1,0,1] neg_lo:[0,1,0]
    v_pk_fma_f32 v[86:87], v[70:71], v[64:65], v[86:87] op_sel:[1,1,0] op_sel_hi:[1,0,1] neg_lo:[0,1,0]
    v_cvt_pk_bf16_f32 v104, v100, v101
    v_cvt_pk_bf16_f32 v108, v86, -v87
    ds_write2_b32 v10, v103, v104 offset0:40 offset1:44
    v_pk_mul_f32 v[88:89], v[72:73], v[64:65] op_sel:[0,0] op_sel_hi:[0,1]
    v_pk_mul_f32 v[98:99], v[100:101], v[62:63] op_sel:[0,0] op_sel_hi:[0,1]
    v_pk_fma_f32 v[88:89], v[72:73], v[64:65], v[88:89] op_sel:[1,1,0] op_sel_hi:[1,0,1] neg_lo:[0,1,0]
    v_pk_fma_f32 v[98:99], v[100:101], v[62:63], v[98:99] op_sel:[1,1,0] op_sel_hi:[1,0,1] neg_lo:[0,1,0]
    v_cvt_pk_bf16_f32 v109, v88, -v89
    v_cvt_pk_bf16_f32 v105, v98, v99
    ds_write2_b32 v9, v108, v109 offset0:40 offset1:44
    v_pk_mul_f32 v[100:101], v[98:99], v[62:63] op_sel:[0,0] op_sel_hi:[0,1]
    v_pk_mul_f32 v[90:91], v[74:75], v[64:65] op_sel:[0,0] op_sel_hi:[0,1]
    v_pk_fma_f32 v[100:101], v[98:99], v[62:63], v[100:101] op_sel:[1,1,0] op_sel_hi:[1,0,1] neg_lo:[0,1,0]
    v_pk_fma_f32 v[90:91], v[74:75], v[64:65], v[90:91] op_sel:[1,1,0] op_sel_hi:[1,0,1] neg_lo:[0,1,0]
    v_cvt_pk_bf16_f32 v102, v100, v101
    v_cvt_pk_bf16_f32 v106, v90, -v91
    ds_write2_b32 v10, v105, v102 offset0:48 offset1:52
    v_pk_mul_f32 v[92:93], v[76:77], v[64:65] op_sel:[0,0] op_sel_hi:[0,1]
    v_pk_mul_f32 v[98:99], v[100:101], v[62:63] op_sel:[0,0] op_sel_hi:[0,1]
    v_pk_fma_f32 v[92:93], v[76:77], v[64:65], v[92:93] op_sel:[1,1,0] op_sel_hi:[1,0,1] neg_lo:[0,1,0]
    v_pk_fma_f32 v[98:99], v[100:101], v[62:63], v[98:99] op_sel:[1,1,0] op_sel_hi:[1,0,1] neg_lo:[0,1,0]
    v_cvt_pk_bf16_f32 v107, v92, -v93
    v_cvt_pk_bf16_f32 v103, v98, v99
    ds_write2_b32 v9, v106, v107 offset0:48 offset1:52
    v_pk_mul_f32 v[100:101], v[98:99], v[62:63] op_sel:[0,0] op_sel_hi:[0,1]
    v_pk_mul_f32 v[94:95], v[78:79], v[64:65] op_sel:[0,0] op_sel_hi:[0,1]
    v_pk_fma_f32 v[100:101], v[98:99], v[62:63], v[100:101] op_sel:[1,1,0] op_sel_hi:[1,0,1] neg_lo:[0,1,0]
    v_pk_fma_f32 v[94:95], v[78:79], v[64:65], v[94:95] op_sel:[1,1,0] op_sel_hi:[1,0,1] neg_lo:[0,1,0]
    v_cvt_pk_bf16_f32 v104, v100, v101
    v_cvt_pk_bf16_f32 v108, v94, -v95
    ds_write2_b32 v10, v103, v104 offset0:56 offset1:60
    v_pk_mul_f32 v[96:97], v[80:81], v[64:65] op_sel:[0,0] op_sel_hi:[0,1]
    v_pk_fma_f32 v[96:97], v[80:81], v[64:65], v[96:97] op_sel:[1,1,0] op_sel_hi:[1,0,1] neg_lo:[0,1,0]
    v_cvt_pk_bf16_f32 v109, v96, -v97
    ds_write2_b32 v9, v108, v109 offset0:56 offset1:60
    ds_read_b128 v[120:123], v11 offset:0
    ds_read_b128 v[136:139], v11 offset:4352
    ds_read_b128 v[124:127], v11 offset:1088
    ds_read_b128 v[140:143], v11 offset:5440
    ds_read_b128 v[128:131], v11 offset:2176
    ds_read_b128 v[144:147], v11 offset:6528
    ds_read_b128 v[132:135], v11 offset:3264
    ds_read_b128 v[148:151], v11 offset:7616
    v_pk_mul_f32 v[66:67], v[82:83], v[64:65] op_sel:[0,0] op_sel_hi:[0,1]
    v_pk_mul_f32 v[68:69], v[86:87], v[64:65] op_sel:[0,0] op_sel_hi:[0,1]
    v_pk_mul_f32 v[70:71], v[90:91], v[64:65] op_sel:[0,0] op_sel_hi:[0,1]
    v_pk_mul_f32 v[72:73], v[94:95], v[64:65] op_sel:[0,0] op_sel_hi:[0,1]
    v_pk_fma_f32 v[66:67], v[82:83], v[64:65], v[66:67] op_sel:[1,1,0] op_sel_hi:[1,0,1] neg_lo:[0,1,0]
    v_pk_fma_f32 v[68:69], v[86:87], v[64:65], v[68:69] op_sel:[1,1,0] op_sel_hi:[1,0,1] neg_lo:[0,1,0]
    v_pk_fma_f32 v[70:71], v[90:91], v[64:65], v[70:71] op_sel:[1,1,0] op_sel_hi:[1,0,1] neg_lo:[0,1,0]
    v_pk_fma_f32 v[72:73], v[94:95], v[64:65], v[72:73] op_sel:[1,1,0] op_sel_hi:[1,0,1] neg_lo:[0,1,0]
    v_cvt_pk_bf16_f32 v110, v66, -v67
    v_cvt_pk_bf16_f32 v111, v68, -v69
    v_cvt_pk_bf16_f32 v112, v70, -v71
    v_cvt_pk_bf16_f32 v113, v72, -v73
    v_pk_mul_f32 v[74:75], v[66:67], v[64:65] op_sel:[0,0] op_sel_hi:[0,1]
    v_pk_mul_f32 v[76:77], v[68:69], v[64:65] op_sel:[0,0] op_sel_hi:[0,1]
    v_pk_mul_f32 v[78:79], v[70:71], v[64:65] op_sel:[0,0] op_sel_hi:[0,1]
    v_pk_mul_f32 v[80:81], v[72:73], v[64:65] op_sel:[0,0] op_sel_hi:[0,1]
    v_pk_fma_f32 v[74:75], v[66:67], v[64:65], v[74:75] op_sel:[1,1,0] op_sel_hi:[1,0,1] neg_lo:[0,1,0]
    v_pk_fma_f32 v[76:77], v[68:69], v[64:65], v[76:77] op_sel:[1,1,0] op_sel_hi:[1,0,1] neg_lo:[0,1,0]
    v_pk_fma_f32 v[78:79], v[70:71], v[64:65], v[78:79] op_sel:[1,1,0] op_sel_hi:[1,0,1] neg_lo:[0,1,0]
    v_pk_fma_f32 v[80:81], v[72:73], v[64:65], v[80:81] op_sel:[1,1,0] op_sel_hi:[1,0,1] neg_lo:[0,1,0]
    v_cvt_pk_bf16_f32 v114, v74, -v75
    v_cvt_pk_bf16_f32 v115, v76, -v77
    v_cvt_pk_bf16_f32 v116, v78, -v79
    v_cvt_pk_bf16_f32 v117, v80, -v81
    v_pk_mul_f32 v[82:83], v[74:75], v[64:65] op_sel:[0,0] op_sel_hi:[0,1]
    v_pk_mul_f32 v[86:87], v[78:79], v[64:65] op_sel:[0,0] op_sel_hi:[0,1]
    v_pk_fma_f32 v[82:83], v[74:75], v[64:65], v[82:83] op_sel:[1,1,0] op_sel_hi:[1,0,1] neg_lo:[0,1,0]
    v_pk_fma_f32 v[86:87], v[78:79], v[64:65], v[86:87] op_sel:[1,1,0] op_sel_hi:[1,0,1] neg_lo:[0,1,0]
    v_cvt_pk_bf16_f32 v102, v82, -v83
    v_cvt_pk_bf16_f32 v106, v86, -v87
    v_pk_mul_f32 v[84:85], v[82:83], v[64:65] op_sel:[0,0] op_sel_hi:[0,1]
    v_pk_mul_f32 v[88:89], v[86:87], v[64:65] op_sel:[0,0] op_sel_hi:[0,1]
    v_pk_fma_f32 v[84:85], v[82:83], v[64:65], v[84:85] op_sel:[1,1,0] op_sel_hi:[1,0,1] neg_lo:[0,1,0]
    v_pk_fma_f32 v[88:89], v[86:87], v[64:65], v[88:89] op_sel:[1,1,0] op_sel_hi:[1,0,1] neg_lo:[0,1,0]
    v_cvt_pk_bf16_f32 v103, v84, -v85
    v_cvt_pk_bf16_f32 v107, v88, -v89
    ds_write2_b32 v9, v102, v103 offset0:0 offset1:4
    ds_write2_b32 v9, v106, v107 offset0:16 offset1:20
    v_pk_mul_f32 v[82:83], v[84:85], v[64:65] op_sel:[0,0] op_sel_hi:[0,1]
    v_pk_mul_f32 v[86:87], v[88:89], v[64:65] op_sel:[0,0] op_sel_hi:[0,1]
    v_pk_fma_f32 v[82:83], v[84:85], v[64:65], v[82:83] op_sel:[1,1,0] op_sel_hi:[1,0,1] neg_lo:[0,1,0]
    v_pk_fma_f32 v[86:87], v[88:89], v[64:65], v[86:87] op_sel:[1,1,0] op_sel_hi:[1,0,1] neg_lo:[0,1,0]
    v_cvt_pk_bf16_f32 v104, v82, -v83
    v_cvt_pk_bf16_f32 v108, v86, -v87
    v_pk_mul_f32 v[84:85], v[82:83], v[64:65] op_sel:[0,0] op_sel_hi:[0,1]
    v_pk_mul_f32 v[88:89], v[86:87], v[64:65] op_sel:[0,0] op_sel_hi:[0,1]
    v_pk_fma_f32 v[84:85], v[82:83], v[64:65], v[84:85] op_sel:[1,1,0] op_sel_hi:[1,0,1] neg_lo:[0,1,0]
    v_pk_fma_f32 v[88:89], v[86:87], v[64:65], v[88:89] op_sel:[1,1,0] op_sel_hi:[1,0,1] neg_lo:[0,1,0]
    v_cvt_pk_bf16_f32 v105, v84, -v85
    v_cvt_pk_bf16_f32 v109, v88, -v89
    ds_write2_b32 v9, v104, v105 offset0:8 offset1:12
    ds_write2_b32 v9, v108, v109 offset0:24 offset1:28
    v_pk_mul_f32 v[82:83], v[84:85], v[64:65] op_sel:[0,0] op_sel_hi:[0,1]
    v_pk_fma_f32 v[82:83], v[84:85], v[64:65], v[82:83] op_sel:[1,1,0] op_sel_hi:[1,0,1] neg_lo:[0,1,0]
    v_cvt_pk_bf16_f32 v102, v82, -v83
    v_pk_mul_f32 v[84:85], v[82:83], v[64:65] op_sel:[0,0] op_sel_hi:[0,1]
    v_pk_fma_f32 v[84:85], v[82:83], v[64:65], v[84:85] op_sel:[1,1,0] op_sel_hi:[1,0,1] neg_lo:[0,1,0]
    v_cvt_pk_bf16_f32 v103, v84, -v85
    ds_write2_b32 v9, v102, v103 offset0:32 offset1:36
    v_pk_mul_f32 v[82:83], v[84:85], v[64:65] op_sel:[0,0] op_sel_hi:[0,1]
    v_pk_fma_f32 v[82:83], v[84:85], v[64:65], v[82:83] op_sel:[1,1,0] op_sel_hi:[1,0,1] neg_lo:[0,1,0]
    v_cvt_pk_bf16_f32 v104, v82, -v83
    v_pk_mul_f32 v[84:85], v[82:83], v[64:65] op_sel:[0,0] op_sel_hi:[0,1]
    v_pk_fma_f32 v[84:85], v[82:83], v[64:65], v[84:85] op_sel:[1,1,0] op_sel_hi:[1,0,1] neg_lo:[0,1,0]
    v_cvt_pk_bf16_f32 v105, v84, -v85
    ds_write2_b32 v9, v104, v105 offset0:40 offset1:44
    v_pk_mul_f32 v[82:83], v[84:85], v[64:65] op_sel:[0,0] op_sel_hi:[0,1]
    v_pk_fma_f32 v[82:83], v[84:85], v[64:65], v[82:83] op_sel:[1,1,0] op_sel_hi:[1,0,1] neg_lo:[0,1,0]
    v_cvt_pk_bf16_f32 v102, v82, -v83
    v_pk_mul_f32 v[84:85], v[82:83], v[64:65] op_sel:[0,0] op_sel_hi:[0,1]
    v_pk_fma_f32 v[84:85], v[82:83], v[64:65], v[84:85] op_sel:[1,1,0] op_sel_hi:[1,0,1] neg_lo:[0,1,0]
    v_cvt_pk_bf16_f32 v103, v84, -v85
    ds_write2_b32 v9, v102, v103 offset0:48 offset1:52
    v_pk_mul_f32 v[82:83], v[84:85], v[64:65] op_sel:[0,0] op_sel_hi:[0,1]
    v_pk_fma_f32 v[82:83], v[84:85], v[64:65], v[82:83] op_sel:[1,1,0] op_sel_hi:[1,0,1] neg_lo:[0,1,0]
    v_cvt_pk_bf16_f32 v104, v82, -v83
    v_pk_mul_f32 v[84:85], v[82:83], v[64:65] op_sel:[0,0] op_sel_hi:[0,1]
    v_pk_fma_f32 v[84:85], v[82:83], v[64:65], v[84:85] op_sel:[1,1,0] op_sel_hi:[1,0,1] neg_lo:[0,1,0]
    v_cvt_pk_bf16_f32 v105, v84, -v85
    ds_write2_b32 v9, v104, v105 offset0:56 offset1:60
    ds_read_b128 v[152:155], v11 offset:4352
    ds_read_b128 v[156:159], v11 offset:5440
    ds_read_b128 v[160:163], v11 offset:6528
    ds_read_b128 v[164:167], v11 offset:7616
    v_pk_mul_f32 v[90:91], v[84:85], v[64:65] op_sel:[0,0] op_sel_hi:[0,1]
    v_pk_fma_f32 v[90:91], v[84:85], v[64:65], v[90:91] op_sel:[1,1,0] op_sel_hi:[1,0,1] neg_lo:[0,1,0]
    s_waitcnt lgkmcnt(12)
    v_mfma_f32_16x16x32_bf16 v[168:171], v[136:139], v[120:123], 0
    ds_write2_b32 v9, v110, v111 offset0:0 offset1:4
    v_mfma_f32_16x16x32_bf16 v[168:171], v[140:143], v[124:127], v[168:171]
    ds_write2_b32 v9, v112, v113 offset0:8 offset1:12
    v_mfma_f32_16x16x32_bf16 v[168:171], v[144:147], v[128:131], v[168:171]
    ds_write2_b32 v9, v114, v115 offset0:16 offset1:20
    v_mfma_f32_16x16x32_bf16 v[168:171], v[148:151], v[132:135], v[168:171]
    ds_write2_b32 v9, v116, v117 offset0:24 offset1:28
    v_cvt_pk_bf16_f32 v102, v90, -v91
    ds_write_b32 v9, v102 offset:128
    ds_read_b128 v[184:187], v11 offset:4352
    ds_read_b128 v[188:191], v11 offset:5440
    ds_read_b128 v[192:195], v11 offset:6528
    ds_read_b128 v[196:199], v11 offset:7616
    v_and_b32 v2, 0xffff0000, v44
    v_mul_f32 v2, 1069066811, v2
    v_exp_f32 v2, v2
    v_and_b32 v3, 0xffff0000, v45
    v_and_b32 v66, 0xffff0000, v46
    v_cvt_pk_bf16_f32 v2, v2, v2
    v_and_b32 v67, 0xffff0000, v47
    s_waitcnt lgkmcnt(0)
    v_and_b32 v2, 0xffff0000, v2
    v_mul_f32 v3, v3, v56
    v_mul_f32 v2, v2, v56
    v_mfma_f32_16x16x32_bf16 v[172:175], v[152:155], v[120:123], 0
    v_mul_f32 v66, v66, v58
    v_mul_f32 v67, v67, v58
    v_mul_f32 v3, 1042479491, v3
    v_mfma_f32_16x16x32_bf16 v[172:175], v[156:159], v[124:127], v[172:175]
    v_mul_f32 v2, 0xbfb8aa3b, v2
    v_mul_f32 v4, 0x41000000, v2
    v_mul_f32 v5, 0x41000000, v3
    v_mfma_f32_16x16x32_bf16 v[172:175], v[160:163], v[128:131], v[172:175]
    v_mul_f32 v6, 0x43000000, v2
    v_mul_f32 v7, 0x43000000, v3
    v_fract_f32 v3, v3
    v_mfma_f32_16x16x32_bf16 v[172:175], v[164:167], v[132:135], v[172:175]
    v_fract_f32 v5, v5
    v_fract_f32 v7, v7
    v_exp_f32 v2, v2
    v_mfma_f32_16x16x32_bf16 v[176:179], v[184:187], v[120:123], 0
    v_exp_f32 v4, v4
    v_exp_f32 v6, v6
    v_cos_f32 v60, v3
    v_mfma_f32_16x16x32_bf16 v[176:179], v[188:191], v[124:127], v[176:179]
    v_sin_f32 v61, v3
    v_cos_f32 v62, v5
    v_sin_f32 v63, v5
    v_mfma_f32_16x16x32_bf16 v[176:179], v[192:195], v[128:131], v[176:179]
    v_cos_f32 v64, v7
    v_sin_f32 v65, v7
    v_mul_f32 v60, v60, v2
    v_mfma_f32_16x16x32_bf16 v[176:179], v[196:199], v[132:135], v[176:179]
    v_mul_f32 v61, v61, v2
    v_mul_f32 v62, v62, v4
    v_mul_f32 v63, v63, v4
    v_mul_f32 v64, v64, v6
    v_mul_f32 v65, v65, v6
    v_cvt_pk_bf16_f32 v102, v62, v63
    v_cvt_pk_bf16_f32 v106, v66, -v67
    ds_write2_b32 v10, v59, v102 offset0:0 offset1:4
    v_pk_mul_f32 v[68:69], v[66:67], v[60:61] op_sel:[0,0] op_sel_hi:[0,1]
    v_pk_mul_f32 v[98:99], v[62:63], v[62:63] op_sel:[0,0] op_sel_hi:[0,1]
    v_pk_fma_f32 v[68:69], v[66:67], v[60:61], v[68:69] op_sel:[1,1,0] op_sel_hi:[1,0,1] neg_lo:[0,1,0]
    v_pk_fma_f32 v[98:99], v[62:63], v[62:63], v[98:99] op_sel:[1,1,0] op_sel_hi:[1,0,1] neg_lo:[0,1,0]
    v_cvt_pk_bf16_f32 v107, v68, -v69
    v_cvt_pk_bf16_f32 v103, v98, v99
    ds_write2_b32 v9, v106, v107 offset0:0 offset1:4
    v_pk_mul_f32 v[100:101], v[98:99], v[62:63] op_sel:[0,0] op_sel_hi:[0,1]
    v_pk_mul_f32 v[70:71], v[68:69], v[60:61] op_sel:[0,0] op_sel_hi:[0,1]
    v_pk_fma_f32 v[100:101], v[98:99], v[62:63], v[100:101] op_sel:[1,1,0] op_sel_hi:[1,0,1] neg_lo:[0,1,0]
    v_pk_fma_f32 v[70:71], v[68:69], v[60:61], v[70:71] op_sel:[1,1,0] op_sel_hi:[1,0,1] neg_lo:[0,1,0]
    v_cvt_pk_bf16_f32 v104, v100, v101
    v_cvt_pk_bf16_f32 v108, v70, -v71
    ds_write2_b32 v10, v103, v104 offset0:8 offset1:12
    v_pk_mul_f32 v[72:73], v[70:71], v[60:61] op_sel:[0,0] op_sel_hi:[0,1]
    v_pk_mul_f32 v[98:99], v[100:101], v[62:63] op_sel:[0,0] op_sel_hi:[0,1]
    v_pk_fma_f32 v[72:73], v[70:71], v[60:61], v[72:73] op_sel:[1,1,0] op_sel_hi:[1,0,1] neg_lo:[0,1,0]
    v_pk_fma_f32 v[98:99], v[100:101], v[62:63], v[98:99] op_sel:[1,1,0] op_sel_hi:[1,0,1] neg_lo:[0,1,0]
    v_cvt_pk_bf16_f32 v109, v72, -v73
    v_cvt_pk_bf16_f32 v105, v98, v99
    ds_write2_b32 v9, v108, v109 offset0:8 offset1:12
    v_pk_mul_f32 v[100:101], v[98:99], v[62:63] op_sel:[0,0] op_sel_hi:[0,1]
    v_pk_mul_f32 v[74:75], v[72:73], v[60:61] op_sel:[0,0] op_sel_hi:[0,1]
    v_pk_fma_f32 v[100:101], v[98:99], v[62:63], v[100:101] op_sel:[1,1,0] op_sel_hi:[1,0,1] neg_lo:[0,1,0]
    v_pk_fma_f32 v[74:75], v[72:73], v[60:61], v[74:75] op_sel:[1,1,0] op_sel_hi:[1,0,1] neg_lo:[0,1,0]
    v_cvt_pk_bf16_f32 v102, v100, v101
    v_cvt_pk_bf16_f32 v106, v74, -v75
    ds_write2_b32 v10, v105, v102 offset0:16 offset1:20
    v_pk_mul_f32 v[76:77], v[74:75], v[60:61] op_sel:[0,0] op_sel_hi:[0,1]
    v_pk_mul_f32 v[98:99], v[100:101], v[62:63] op_sel:[0,0] op_sel_hi:[0,1]
    v_pk_fma_f32 v[76:77], v[74:75], v[60:61], v[76:77] op_sel:[1,1,0] op_sel_hi:[1,0,1] neg_lo:[0,1,0]
    v_pk_fma_f32 v[98:99], v[100:101], v[62:63], v[98:99] op_sel:[1,1,0] op_sel_hi:[1,0,1] neg_lo:[0,1,0]
    v_cvt_pk_bf16_f32 v107, v76, -v77
    v_cvt_pk_bf16_f32 v103, v98, v99
    ds_write2_b32 v9, v106, v107 offset0:16 offset1:20
    v_pk_mul_f32 v[100:101], v[98:99], v[62:63] op_sel:[0,0] op_sel_hi:[0,1]
    v_pk_mul_f32 v[78:79], v[76:77], v[60:61] op_sel:[0,0] op_sel_hi:[0,1]
    v_pk_fma_f32 v[100:101], v[98:99], v[62:63], v[100:101] op_sel:[1,1,0] op_sel_hi:[1,0,1] neg_lo:[0,1,0]
    v_pk_fma_f32 v[78:79], v[76:77], v[60:61], v[78:79] op_sel:[1,1,0] op_sel_hi:[1,0,1] neg_lo:[0,1,0]
    v_cvt_pk_bf16_f32 v104, v100, v101
    v_cvt_pk_bf16_f32 v108, v78, -v79
    ds_write2_b32 v10, v103, v104 offset0:24 offset1:28
    v_pk_mul_f32 v[80:81], v[78:79], v[60:61] op_sel:[0,0] op_sel_hi:[0,1]
    v_pk_mul_f32 v[98:99], v[100:101], v[62:63] op_sel:[0,0] op_sel_hi:[0,1]
    v_pk_fma_f32 v[80:81], v[78:79], v[60:61], v[80:81] op_sel:[1,1,0] op_sel_hi:[1,0,1] neg_lo:[0,1,0]
    v_pk_fma_f32 v[98:99], v[100:101], v[62:63], v[98:99] op_sel:[1,1,0] op_sel_hi:[1,0,1] neg_lo:[0,1,0]
    v_cvt_pk_bf16_f32 v109, v80, -v81
    v_cvt_pk_bf16_f32 v105, v98, v99
    ds_write2_b32 v9, v108, v109 offset0:24 offset1:28
    v_pk_mul_f32 v[100:101], v[98:99], v[62:63] op_sel:[0,0] op_sel_hi:[0,1]
    v_pk_mul_f32 v[82:83], v[66:67], v[64:65] op_sel:[0,0] op_sel_hi:[0,1]
    v_pk_fma_f32 v[100:101], v[98:99], v[62:63], v[100:101] op_sel:[1,1,0] op_sel_hi:[1,0,1] neg_lo:[0,1,0]
    v_pk_fma_f32 v[82:83], v[66:67], v[64:65], v[82:83] op_sel:[1,1,0] op_sel_hi:[1,0,1] neg_lo:[0,1,0]
    v_cvt_pk_bf16_f32 v102, v100, v101
    v_cvt_pk_bf16_f32 v106, v82, -v83
    ds_write2_b32 v10, v105, v102 offset0:32 offset1:36
    v_pk_mul_f32 v[84:85], v[68:69], v[64:65] op_sel:[0,0] op_sel_hi:[0,1]
    v_pk_mul_f32 v[98:99], v[100:101], v[62:63] op_sel:[0,0] op_sel_hi:[0,1]
    v_pk_fma_f32 v[84:85], v[68:69], v[64:65], v[84:85] op_sel:[1,1,0] op_sel_hi:[1,0,1] neg_lo:[0,1,0]
    v_pk_fma_f32 v[98:99], v[100:101], v[62:63], v[98:99] op_sel:[1,1,0] op_sel_hi:[1,0,1] neg_lo:[0,1,0]
    v_cvt_pk_bf16_f32 v107, v84, -v85
    v_cvt_pk_bf16_f32 v103, v98, v99
    ds_write2_b32 v9, v106, v107 offset0:32 offset1:36
    v_pk_mul_f32 v[100:101], v[98:99], v[62:63] op_sel:[0,0] op_sel_hi:[0,1]
    v_pk_mul_f32 v[86:87], v[70:71], v[64:65] op_sel:[0,0] op_sel_hi:[0,1]
    v_pk_fma_f32 v[100:101], v[98:99], v[62:63], v[100:101] op_sel:[1,1,0] op_sel_hi:[1,0,1] neg_lo:[0,1,0]
    v_pk_fma_f32 v[86:87], v[70:71], v[64:65], v[86:87] op_sel:[1,1,0] op_sel_hi:[1,0,1] neg_lo:[0,1,0]
    v_cvt_pk_bf16_f32 v104, v100, v101
    v_cvt_pk_bf16_f32 v108, v86, -v87
    ds_write2_b32 v10, v103, v104 offset0:40 offset1:44
    v_pk_mul_f32 v[88:89], v[72:73], v[64:65] op_sel:[0,0] op_sel_hi:[0,1]
    v_pk_mul_f32 v[98:99], v[100:101], v[62:63] op_sel:[0,0] op_sel_hi:[0,1]
    v_pk_fma_f32 v[88:89], v[72:73], v[64:65], v[88:89] op_sel:[1,1,0] op_sel_hi:[1,0,1] neg_lo:[0,1,0]
    v_pk_fma_f32 v[98:99], v[100:101], v[62:63], v[98:99] op_sel:[1,1,0] op_sel_hi:[1,0,1] neg_lo:[0,1,0]
    v_cvt_pk_bf16_f32 v109, v88, -v89
    v_cvt_pk_bf16_f32 v105, v98, v99
    ds_write2_b32 v9, v108, v109 offset0:40 offset1:44
    v_pk_mul_f32 v[100:101], v[98:99], v[62:63] op_sel:[0,0] op_sel_hi:[0,1]
    v_pk_mul_f32 v[90:91], v[74:75], v[64:65] op_sel:[0,0] op_sel_hi:[0,1]
    v_pk_fma_f32 v[100:101], v[98:99], v[62:63], v[100:101] op_sel:[1,1,0] op_sel_hi:[1,0,1] neg_lo:[0,1,0]
    v_pk_fma_f32 v[90:91], v[74:75], v[64:65], v[90:91] op_sel:[1,1,0] op_sel_hi:[1,0,1] neg_lo:[0,1,0]
    v_cvt_pk_bf16_f32 v102, v100, v101
    v_cvt_pk_bf16_f32 v106, v90, -v91
    ds_write2_b32 v10, v105, v102 offset0:48 offset1:52
    v_pk_mul_f32 v[92:93], v[76:77], v[64:65] op_sel:[0,0] op_sel_hi:[0,1]
    v_pk_mul_f32 v[98:99], v[100:101], v[62:63] op_sel:[0,0] op_sel_hi:[0,1]
    v_pk_fma_f32 v[92:93], v[76:77], v[64:65], v[92:93] op_sel:[1,1,0] op_sel_hi:[1,0,1] neg_lo:[0,1,0]
    v_pk_fma_f32 v[98:99], v[100:101], v[62:63], v[98:99] op_sel:[1,1,0] op_sel_hi:[1,0,1] neg_lo:[0,1,0]
    v_cvt_pk_bf16_f32 v107, v92, -v93
    v_cvt_pk_bf16_f32 v103, v98, v99
    ds_write2_b32 v9, v106, v107 offset0:48 offset1:52
    v_pk_mul_f32 v[100:101], v[98:99], v[62:63] op_sel:[0,0] op_sel_hi:[0,1]
    v_pk_mul_f32 v[94:95], v[78:79], v[64:65] op_sel:[0,0] op_sel_hi:[0,1]
    v_pk_fma_f32 v[100:101], v[98:99], v[62:63], v[100:101] op_sel:[1,1,0] op_sel_hi:[1,0,1] neg_lo:[0,1,0]
    v_pk_fma_f32 v[94:95], v[78:79], v[64:65], v[94:95] op_sel:[1,1,0] op_sel_hi:[1,0,1] neg_lo:[0,1,0]
    v_cvt_pk_bf16_f32 v104, v100, v101
    v_cvt_pk_bf16_f32 v108, v94, -v95
    ds_write2_b32 v10, v103, v104 offset0:56 offset1:60
    v_pk_mul_f32 v[96:97], v[80:81], v[64:65] op_sel:[0,0] op_sel_hi:[0,1]
    v_pk_fma_f32 v[96:97], v[80:81], v[64:65], v[96:97] op_sel:[1,1,0] op_sel_hi:[1,0,1] neg_lo:[0,1,0]
    v_cvt_pk_bf16_f32 v109, v96, -v97
    ds_write2_b32 v9, v108, v109 offset0:56 offset1:60
    ds_read_b128 v[120:123], v11 offset:0
    ds_read_b128 v[136:139], v11 offset:4352
    ds_read_b128 v[124:127], v11 offset:1088
    ds_read_b128 v[140:143], v11 offset:5440
    ds_read_b128 v[128:131], v11 offset:2176
    ds_read_b128 v[144:147], v11 offset:6528
    ds_read_b128 v[132:135], v11 offset:3264
    ds_read_b128 v[148:151], v11 offset:7616
    v_pk_mul_f32 v[66:67], v[82:83], v[64:65] op_sel:[0,0] op_sel_hi:[0,1]
    v_pk_mul_f32 v[68:69], v[86:87], v[64:65] op_sel:[0,0] op_sel_hi:[0,1]
    v_pk_mul_f32 v[70:71], v[90:91], v[64:65] op_sel:[0,0] op_sel_hi:[0,1]
    v_pk_mul_f32 v[72:73], v[94:95], v[64:65] op_sel:[0,0] op_sel_hi:[0,1]
    v_pk_fma_f32 v[66:67], v[82:83], v[64:65], v[66:67] op_sel:[1,1,0] op_sel_hi:[1,0,1] neg_lo:[0,1,0]
    v_pk_fma_f32 v[68:69], v[86:87], v[64:65], v[68:69] op_sel:[1,1,0] op_sel_hi:[1,0,1] neg_lo:[0,1,0]
    v_pk_fma_f32 v[70:71], v[90:91], v[64:65], v[70:71] op_sel:[1,1,0] op_sel_hi:[1,0,1] neg_lo:[0,1,0]
    v_pk_fma_f32 v[72:73], v[94:95], v[64:65], v[72:73] op_sel:[1,1,0] op_sel_hi:[1,0,1] neg_lo:[0,1,0]
    v_cvt_pk_bf16_f32 v110, v66, -v67
    v_cvt_pk_bf16_f32 v111, v68, -v69
    v_cvt_pk_bf16_f32 v112, v70, -v71
    v_cvt_pk_bf16_f32 v113, v72, -v73
    v_pk_mul_f32 v[74:75], v[66:67], v[64:65] op_sel:[0,0] op_sel_hi:[0,1]
    v_pk_mul_f32 v[76:77], v[68:69], v[64:65] op_sel:[0,0] op_sel_hi:[0,1]
    v_pk_mul_f32 v[78:79], v[70:71], v[64:65] op_sel:[0,0] op_sel_hi:[0,1]
    v_pk_mul_f32 v[80:81], v[72:73], v[64:65] op_sel:[0,0] op_sel_hi:[0,1]
    v_pk_fma_f32 v[74:75], v[66:67], v[64:65], v[74:75] op_sel:[1,1,0] op_sel_hi:[1,0,1] neg_lo:[0,1,0]
    v_pk_fma_f32 v[76:77], v[68:69], v[64:65], v[76:77] op_sel:[1,1,0] op_sel_hi:[1,0,1] neg_lo:[0,1,0]
    v_pk_fma_f32 v[78:79], v[70:71], v[64:65], v[78:79] op_sel:[1,1,0] op_sel_hi:[1,0,1] neg_lo:[0,1,0]
    v_pk_fma_f32 v[80:81], v[72:73], v[64:65], v[80:81] op_sel:[1,1,0] op_sel_hi:[1,0,1] neg_lo:[0,1,0]
    v_cvt_pk_bf16_f32 v114, v74, -v75
    v_cvt_pk_bf16_f32 v115, v76, -v77
    v_cvt_pk_bf16_f32 v116, v78, -v79
    v_cvt_pk_bf16_f32 v117, v80, -v81
    v_pk_mul_f32 v[82:83], v[74:75], v[64:65] op_sel:[0,0] op_sel_hi:[0,1]
    v_pk_mul_f32 v[86:87], v[78:79], v[64:65] op_sel:[0,0] op_sel_hi:[0,1]
    v_pk_fma_f32 v[82:83], v[74:75], v[64:65], v[82:83] op_sel:[1,1,0] op_sel_hi:[1,0,1] neg_lo:[0,1,0]
    v_pk_fma_f32 v[86:87], v[78:79], v[64:65], v[86:87] op_sel:[1,1,0] op_sel_hi:[1,0,1] neg_lo:[0,1,0]
    v_cvt_pk_bf16_f32 v102, v82, -v83
    v_cvt_pk_bf16_f32 v106, v86, -v87
    v_pk_mul_f32 v[84:85], v[82:83], v[64:65] op_sel:[0,0] op_sel_hi:[0,1]
    v_pk_mul_f32 v[88:89], v[86:87], v[64:65] op_sel:[0,0] op_sel_hi:[0,1]
    v_pk_fma_f32 v[84:85], v[82:83], v[64:65], v[84:85] op_sel:[1,1,0] op_sel_hi:[1,0,1] neg_lo:[0,1,0]
    v_pk_fma_f32 v[88:89], v[86:87], v[64:65], v[88:89] op_sel:[1,1,0] op_sel_hi:[1,0,1] neg_lo:[0,1,0]
    v_cvt_pk_bf16_f32 v103, v84, -v85
    v_cvt_pk_bf16_f32 v107, v88, -v89
    ds_write2_b32 v9, v102, v103 offset0:0 offset1:4
    ds_write2_b32 v9, v106, v107 offset0:16 offset1:20
    v_pk_mul_f32 v[82:83], v[84:85], v[64:65] op_sel:[0,0] op_sel_hi:[0,1]
    v_pk_mul_f32 v[86:87], v[88:89], v[64:65] op_sel:[0,0] op_sel_hi:[0,1]
    v_pk_fma_f32 v[82:83], v[84:85], v[64:65], v[82:83] op_sel:[1,1,0] op_sel_hi:[1,0,1] neg_lo:[0,1,0]
    v_pk_fma_f32 v[86:87], v[88:89], v[64:65], v[86:87] op_sel:[1,1,0] op_sel_hi:[1,0,1] neg_lo:[0,1,0]
    v_cvt_pk_bf16_f32 v104, v82, -v83
    v_cvt_pk_bf16_f32 v108, v86, -v87
    v_pk_mul_f32 v[84:85], v[82:83], v[64:65] op_sel:[0,0] op_sel_hi:[0,1]
    v_pk_mul_f32 v[88:89], v[86:87], v[64:65] op_sel:[0,0] op_sel_hi:[0,1]
    v_pk_fma_f32 v[84:85], v[82:83], v[64:65], v[84:85] op_sel:[1,1,0] op_sel_hi:[1,0,1] neg_lo:[0,1,0]
    v_pk_fma_f32 v[88:89], v[86:87], v[64:65], v[88:89] op_sel:[1,1,0] op_sel_hi:[1,0,1] neg_lo:[0,1,0]
    v_cvt_pk_bf16_f32 v105, v84, -v85
    v_cvt_pk_bf16_f32 v109, v88, -v89
    ds_write2_b32 v9, v104, v105 offset0:8 offset1:12
    ds_write2_b32 v9, v108, v109 offset0:24 offset1:28
    v_pk_mul_f32 v[82:83], v[84:85], v[64:65] op_sel:[0,0] op_sel_hi:[0,1]
    v_pk_fma_f32 v[82:83], v[84:85], v[64:65], v[82:83] op_sel:[1,1,0] op_sel_hi:[1,0,1] neg_lo:[0,1,0]
    v_cvt_pk_bf16_f32 v102, v82, -v83
    v_pk_mul_f32 v[84:85], v[82:83], v[64:65] op_sel:[0,0] op_sel_hi:[0,1]
    v_pk_fma_f32 v[84:85], v[82:83], v[64:65], v[84:85] op_sel:[1,1,0] op_sel_hi:[1,0,1] neg_lo:[0,1,0]
    v_cvt_pk_bf16_f32 v103, v84, -v85
    ds_write2_b32 v9, v102, v103 offset0:32 offset1:36
    v_pk_mul_f32 v[82:83], v[84:85], v[64:65] op_sel:[0,0] op_sel_hi:[0,1]
    v_pk_fma_f32 v[82:83], v[84:85], v[64:65], v[82:83] op_sel:[1,1,0] op_sel_hi:[1,0,1] neg_lo:[0,1,0]
    v_cvt_pk_bf16_f32 v104, v82, -v83
    v_pk_mul_f32 v[84:85], v[82:83], v[64:65] op_sel:[0,0] op_sel_hi:[0,1]
    v_pk_fma_f32 v[84:85], v[82:83], v[64:65], v[84:85] op_sel:[1,1,0] op_sel_hi:[1,0,1] neg_lo:[0,1,0]
    v_cvt_pk_bf16_f32 v105, v84, -v85
    ds_write2_b32 v9, v104, v105 offset0:40 offset1:44
    v_pk_mul_f32 v[82:83], v[84:85], v[64:65] op_sel:[0,0] op_sel_hi:[0,1]
    v_pk_fma_f32 v[82:83], v[84:85], v[64:65], v[82:83] op_sel:[1,1,0] op_sel_hi:[1,0,1] neg_lo:[0,1,0]
    v_cvt_pk_bf16_f32 v102, v82, -v83
    v_pk_mul_f32 v[84:85], v[82:83], v[64:65] op_sel:[0,0] op_sel_hi:[0,1]
    v_pk_fma_f32 v[84:85], v[82:83], v[64:65], v[84:85] op_sel:[1,1,0] op_sel_hi:[1,0,1] neg_lo:[0,1,0]
    v_cvt_pk_bf16_f32 v103, v84, -v85
    ds_write2_b32 v9, v102, v103 offset0:48 offset1:52
    v_pk_mul_f32 v[82:83], v[84:85], v[64:65] op_sel:[0,0] op_sel_hi:[0,1]
    v_pk_fma_f32 v[82:83], v[84:85], v[64:65], v[82:83] op_sel:[1,1,0] op_sel_hi:[1,0,1] neg_lo:[0,1,0]
    v_cvt_pk_bf16_f32 v104, v82, -v83
    v_pk_mul_f32 v[84:85], v[82:83], v[64:65] op_sel:[0,0] op_sel_hi:[0,1]
    v_pk_fma_f32 v[84:85], v[82:83], v[64:65], v[84:85] op_sel:[1,1,0] op_sel_hi:[1,0,1] neg_lo:[0,1,0]
    v_cvt_pk_bf16_f32 v105, v84, -v85
    ds_write2_b32 v9, v104, v105 offset0:56 offset1:60
    ds_read_b128 v[152:155], v11 offset:4352
    ds_read_b128 v[156:159], v11 offset:5440
    ds_read_b128 v[160:163], v11 offset:6528
    ds_read_b128 v[164:167], v11 offset:7616
    v_pk_mul_f32 v[90:91], v[84:85], v[64:65] op_sel:[0,0] op_sel_hi:[0,1]
    v_pk_fma_f32 v[90:91], v[84:85], v[64:65], v[90:91] op_sel:[1,1,0] op_sel_hi:[1,0,1] neg_lo:[0,1,0]
    s_waitcnt lgkmcnt(12)
    v_mfma_f32_16x16x32_bf16 v[168:171], v[136:139], v[120:123], v[168:171]
    ds_write2_b32 v9, v110, v111 offset0:0 offset1:4
    v_mfma_f32_16x16x32_bf16 v[168:171], v[140:143], v[124:127], v[168:171]
    ds_write2_b32 v9, v112, v113 offset0:8 offset1:12
    v_mfma_f32_16x16x32_bf16 v[168:171], v[144:147], v[128:131], v[168:171]
    ds_write2_b32 v9, v114, v115 offset0:16 offset1:20
    v_mfma_f32_16x16x32_bf16 v[168:171], v[148:151], v[132:135], v[168:171]
    ds_write2_b32 v9, v116, v117 offset0:24 offset1:28
    v_cvt_pk_bf16_f32 v102, v90, -v91
    ds_write_b32 v9, v102 offset:128
    ds_read_b128 v[184:187], v11 offset:4352
    ds_read_b128 v[188:191], v11 offset:5440
    ds_read_b128 v[192:195], v11 offset:6528
    ds_read_b128 v[196:199], v11 offset:7616
    s_waitcnt vmcnt(0)
    v_lshlrev_b32 v2, 16, v48
    v_mul_f32 v2, 1069066811, v2
    v_exp_f32 v2, v2
    v_lshlrev_b32 v3, 16, v49
    v_lshlrev_b32 v66, 16, v50
    v_cvt_pk_bf16_f32 v2, v2, v2
    v_lshlrev_b32 v67, 16, v51
    s_waitcnt lgkmcnt(0)
    v_and_b32 v2, 0xffff0000, v2
    v_mul_f32 v3, v3, v56
    v_mul_f32 v2, v2, v56
    v_mfma_f32_16x16x32_bf16 v[172:175], v[152:155], v[120:123], v[172:175]
    v_mul_f32 v66, v66, v58
    v_mul_f32 v67, v67, v58
    v_mul_f32 v3, 1042479491, v3
    v_mfma_f32_16x16x32_bf16 v[172:175], v[156:159], v[124:127], v[172:175]
    v_mul_f32 v2, 0xbfb8aa3b, v2
    v_mul_f32 v4, 0x41000000, v2
    v_mul_f32 v5, 0x41000000, v3
    v_mfma_f32_16x16x32_bf16 v[172:175], v[160:163], v[128:131], v[172:175]
    v_mul_f32 v6, 0x43000000, v2
    v_mul_f32 v7, 0x43000000, v3
    v_fract_f32 v3, v3
    v_mfma_f32_16x16x32_bf16 v[172:175], v[164:167], v[132:135], v[172:175]
    v_fract_f32 v5, v5
    v_fract_f32 v7, v7
    v_exp_f32 v2, v2
    v_mfma_f32_16x16x32_bf16 v[176:179], v[184:187], v[120:123], v[176:179]
    v_exp_f32 v4, v4
    v_exp_f32 v6, v6
    v_cos_f32 v60, v3
    v_mfma_f32_16x16x32_bf16 v[176:179], v[188:191], v[124:127], v[176:179]
    v_sin_f32 v61, v3
    v_cos_f32 v62, v5
    v_sin_f32 v63, v5
    v_mfma_f32_16x16x32_bf16 v[176:179], v[192:195], v[128:131], v[176:179]
    v_cos_f32 v64, v7
    v_sin_f32 v65, v7
    v_mul_f32 v60, v60, v2
    v_mfma_f32_16x16x32_bf16 v[176:179], v[196:199], v[132:135], v[176:179]
    v_mul_f32 v61, v61, v2
    v_mul_f32 v62, v62, v4
    v_mul_f32 v63, v63, v4
    v_mul_f32 v64, v64, v6
    v_mul_f32 v65, v65, v6
    v_cvt_pk_bf16_f32 v102, v62, v63
    v_cvt_pk_bf16_f32 v106, v66, -v67
    ds_write2_b32 v10, v59, v102 offset0:0 offset1:4
    v_mul_f32 v68, v66, v60
    v_mul_f32 v98, v62, v62
    v_mul_f32 v69, v66, v61
    v_mul_f32 v99, v62, v63
    v_fma_f32 v68, -v67, v61, v68
    v_fma_f32 v98, -v63, v63, v98
    v_fma_f32 v69, v67, v60, v69
    v_fma_f32 v99, v63, v62, v99
    v_cvt_pk_bf16_f32 v107, v68, -v69
    v_cvt_pk_bf16_f32 v103, v98, v99
    ds_write2_b32 v9, v106, v107 offset0:0 offset1:4
    v_mul_f32 v100, v98, v62
    v_mul_f32 v70, v68, v60
    v_mul_f32 v101, v98, v63
    v_mul_f32 v71, v68, v61
    v_fma_f32 v100, -v99, v63, v100
    v_fma_f32 v70, -v69, v61, v70
    v_fma_f32 v101, v99, v62, v101
    v_fma_f32 v71, v69, v60, v71
    v_cvt_pk_bf16_f32 v104, v100, v101
    v_cvt_pk_bf16_f32 v108, v70, -v71
    ds_write2_b32 v10, v103, v104 offset0:8 offset1:12
    v_mul_f32 v72, v70, v60
    v_mul_f32 v98, v100, v62
    v_mul_f32 v73, v70, v61
    v_mul_f32 v99, v100, v63
    v_fma_f32 v72, -v71, v61, v72
    v_fma_f32 v98, -v101, v63, v98
    v_fma_f32 v73, v71, v60, v73
    v_fma_f32 v99, v101, v62, v99
    v_cvt_pk_bf16_f32 v109, v72, -v73
    v_cvt_pk_bf16_f32 v105, v98, v99
    ds_write2_b32 v9, v108, v109 offset0:8 offset1:12
    v_mul_f32 v100, v98, v62
    v_mul_f32 v74, v72, v60
    v_mul_f32 v101, v98, v63
    v_mul_f32 v75, v72, v61
    v_fma_f32 v100, -v99, v63, v100
    v_fma_f32 v74, -v73, v61, v74
    v_fma_f32 v101, v99, v62, v101
    v_fma_f32 v75, v73, v60, v75
    v_cvt_pk_bf16_f32 v102, v100, v101
    v_cvt_pk_bf16_f32 v106, v74, -v75
    ds_write2_b32 v10, v105, v102 offset0:16 offset1:20
    v_mul_f32 v76, v74, v60
    v_mul_f32 v98, v100, v62
    v_mul_f32 v77, v74, v61
    v_mul_f32 v99, v100, v63
    v_fma_f32 v76, -v75, v61, v76
    v_fma_f32 v98, -v101, v63, v98
    v_fma_f32 v77, v75, v60, v77
    v_fma_f32 v99, v101, v62, v99
    v_cvt_pk_bf16_f32 v107, v76, -v77
    v_cvt_pk_bf16_f32 v103, v98, v99
    ds_write2_b32 v9, v106, v107 offset0:16 offset1:20
    v_mul_f32 v100, v98, v62
    v_mul_f32 v78, v76, v60
    v_mul_f32 v101, v98, v63
    v_mul_f32 v79, v76, v61
    v_fma_f32 v100, -v99, v63, v100
    v_fma_f32 v78, -v77, v61, v78
    v_fma_f32 v101, v99, v62, v101
    v_fma_f32 v79, v77, v60, v79
    v_cvt_pk_bf16_f32 v104, v100, v101
    v_cvt_pk_bf16_f32 v108, v78, -v79
    ds_write2_b32 v10, v103, v104 offset0:24 offset1:28
    v_mul_f32 v80, v78, v60
    v_mul_f32 v98, v100, v62
    v_mul_f32 v81, v78, v61
    v_mul_f32 v99, v100, v63
    v_fma_f32 v80, -v79, v61, v80
    v_fma_f32 v98, -v101, v63, v98
    v_fma_f32 v81, v79, v60, v81
    v_fma_f32 v99, v101, v62, v99
    v_cvt_pk_bf16_f32 v109, v80, -v81
    v_cvt_pk_bf16_f32 v105, v98, v99
    ds_write2_b32 v9, v108, v109 offset0:24 offset1:28
    v_mul_f32 v100, v98, v62
    v_mul_f32 v82, v66, v64
    v_mul_f32 v101, v98, v63
    v_mul_f32 v83, v66, v65
    v_fma_f32 v100, -v99, v63, v100
    v_fma_f32 v82, -v67, v65, v82
    v_fma_f32 v101, v99, v62, v101
    v_fma_f32 v83, v67, v64, v83
    v_cvt_pk_bf16_f32 v102, v100, v101
    v_cvt_pk_bf16_f32 v106, v82, -v83
    ds_write2_b32 v10, v105, v102 offset0:32 offset1:36
    v_mul_f32 v84, v68, v64
    v_mul_f32 v98, v100, v62
    v_mul_f32 v85, v68, v65
    v_mul_f32 v99, v100, v63
    v_fma_f32 v84, -v69, v65, v84
    v_fma_f32 v98, -v101, v63, v98
    v_fma_f32 v85, v69, v64, v85
    v_fma_f32 v99, v101, v62, v99
    v_cvt_pk_bf16_f32 v107, v84, -v85
    v_cvt_pk_bf16_f32 v103, v98, v99
    ds_write2_b32 v9, v106, v107 offset0:32 offset1:36
    v_mul_f32 v100, v98, v62
    v_mul_f32 v86, v70, v64
    v_mul_f32 v101, v98, v63
    v_mul_f32 v87, v70, v65
    v_fma_f32 v100, -v99, v63, v100
    v_fma_f32 v86, -v71, v65, v86
    v_fma_f32 v101, v99, v62, v101
    v_fma_f32 v87, v71, v64, v87
    v_cvt_pk_bf16_f32 v104, v100, v101
    v_cvt_pk_bf16_f32 v108, v86, -v87
    ds_write2_b32 v10, v103, v104 offset0:40 offset1:44
    v_mul_f32 v88, v72, v64
    v_mul_f32 v98, v100, v62
    v_mul_f32 v89, v72, v65
    v_mul_f32 v99, v100, v63
    v_fma_f32 v88, -v73, v65, v88
    v_fma_f32 v98, -v101, v63, v98
    v_fma_f32 v89, v73, v64, v89
    v_fma_f32 v99, v101, v62, v99
    v_cvt_pk_bf16_f32 v109, v88, -v89
    v_cvt_pk_bf16_f32 v105, v98, v99
    ds_write2_b32 v9, v108, v109 offset0:40 offset1:44
    v_mul_f32 v100, v98, v62
    v_mul_f32 v90, v74, v64
    v_mul_f32 v101, v98, v63
    v_mul_f32 v91, v74, v65
    v_fma_f32 v100, -v99, v63, v100
    v_fma_f32 v90, -v75, v65, v90
    v_fma_f32 v101, v99, v62, v101
    v_fma_f32 v91, v75, v64, v91
    v_cvt_pk_bf16_f32 v102, v100, v101
    v_cvt_pk_bf16_f32 v106, v90, -v91
    ds_write2_b32 v10, v105, v102 offset0:48 offset1:52
    v_mul_f32 v92, v76, v64
    v_mul_f32 v98, v100, v62
    v_mul_f32 v93, v76, v65
    v_mul_f32 v99, v100, v63
    v_fma_f32 v92, -v77, v65, v92
    v_fma_f32 v98, -v101, v63, v98
    v_fma_f32 v93, v77, v64, v93
    v_fma_f32 v99, v101, v62, v99
    v_cvt_pk_bf16_f32 v107, v92, -v93
    v_cvt_pk_bf16_f32 v103, v98, v99
    ds_write2_b32 v9, v106, v107 offset0:48 offset1:52
    v_mul_f32 v100, v98, v62
    v_mul_f32 v94, v78, v64
    v_mul_f32 v101, v98, v63
    v_mul_f32 v95, v78, v65
    v_fma_f32 v100, -v99, v63, v100
    v_fma_f32 v94, -v79, v65, v94
    v_fma_f32 v101, v99, v62, v101
    v_fma_f32 v95, v79, v64, v95
    v_cvt_pk_bf16_f32 v104, v100, v101
    v_cvt_pk_bf16_f32 v108, v94, -v95
    ds_write2_b32 v10, v103, v104 offset0:56 offset1:60
    v_mul_f32 v96, v80, v64
    v_mul_f32 v97, v80, v65
    v_fma_f32 v96, -v81, v65, v96
    v_fma_f32 v97, v81, v64, v97
    v_cvt_pk_bf16_f32 v109, v96, -v97
    ds_write2_b32 v9, v108, v109 offset0:56 offset1:60
    ds_read_b128 v[120:123], v11 offset:0
    ds_read_b128 v[136:139], v11 offset:4352
    ds_read_b128 v[124:127], v11 offset:1088
    ds_read_b128 v[140:143], v11 offset:5440
    ds_read_b128 v[128:131], v11 offset:2176
    ds_read_b128 v[144:147], v11 offset:6528
    ds_read_b128 v[132:135], v11 offset:3264
    ds_read_b128 v[148:151], v11 offset:7616
    v_mul_f32 v66, v82, v64
    v_mul_f32 v68, v86, v64
    v_mul_f32 v70, v90, v64
    v_mul_f32 v72, v94, v64
    v_mul_f32 v67, v82, v65
    v_mul_f32 v69, v86, v65
    v_mul_f32 v71, v90, v65
    v_mul_f32 v73, v94, v65
    v_fma_f32 v66, -v83, v65, v66
    v_fma_f32 v68, -v87, v65, v68
    v_fma_f32 v70, -v91, v65, v70
    v_fma_f32 v72, -v95, v65, v72
    v_fma_f32 v67, v83, v64, v67
    v_fma_f32 v69, v87, v64, v69
    v_fma_f32 v71, v91, v64, v71
    v_fma_f32 v73, v95, v64, v73
    v_cvt_pk_bf16_f32 v110, v66, -v67
    v_cvt_pk_bf16_f32 v111, v68, -v69
    v_cvt_pk_bf16_f32 v112, v70, -v71
    v_cvt_pk_bf16_f32 v113, v72, -v73
    v_mul_f32 v74, v66, v64
    v_mul_f32 v76, v68, v64
    v_mul_f32 v78, v70, v64
    v_mul_f32 v80, v72, v64
    v_mul_f32 v75, v66, v65
    v_mul_f32 v77, v68, v65
    v_mul_f32 v79, v70, v65
    v_mul_f32 v81, v72, v65
    v_fma_f32 v74, -v67, v65, v74
    v_fma_f32 v76, -v69, v65, v76
    v_fma_f32 v78, -v71, v65, v78
    v_fma_f32 v80, -v73, v65, v80
    v_fma_f32 v75, v67, v64, v75
    v_fma_f32 v77, v69, v64, v77
    v_fma_f32 v79, v71, v64, v79
    v_fma_f32 v81, v73, v64, v81
    v_cvt_pk_bf16_f32 v114, v74, -v75
    v_cvt_pk_bf16_f32 v115, v76, -v77
    v_cvt_pk_bf16_f32 v116, v78, -v79
    v_cvt_pk_bf16_f32 v117, v80, -v81
    v_mul_f32 v82, v74, v64
    v_mul_f32 v86, v78, v64
    v_mul_f32 v83, v74, v65
    v_mul_f32 v87, v78, v65
    v_fma_f32 v82, -v75, v65, v82
    v_fma_f32 v86, -v79, v65, v86
    v_fma_f32 v83, v75, v64, v83
    v_fma_f32 v87, v79, v64, v87
    v_cvt_pk_bf16_f32 v102, v82, -v83
    v_cvt_pk_bf16_f32 v106, v86, -v87
    v_mul_f32 v84, v82, v64
    v_mul_f32 v88, v86, v64
    v_mul_f32 v85, v82, v65
    v_mul_f32 v89, v86, v65
    v_fma_f32 v84, -v83, v65, v84
    v_fma_f32 v88, -v87, v65, v88
    v_fma_f32 v85, v83, v64, v85
    v_fma_f32 v89, v87, v64, v89
    v_cvt_pk_bf16_f32 v103, v84, -v85
    v_cvt_pk_bf16_f32 v107, v88, -v89
    ds_write2_b32 v9, v102, v103 offset0:0 offset1:4
    ds_write2_b32 v9, v106, v107 offset0:16 offset1:20
    v_mul_f32 v82, v84, v64
    v_mul_f32 v86, v88, v64
    v_mul_f32 v83, v84, v65
    v_mul_f32 v87, v88, v65
    v_fma_f32 v82, -v85, v65, v82
    v_fma_f32 v86, -v89, v65, v86
    v_fma_f32 v83, v85, v64, v83
    v_fma_f32 v87, v89, v64, v87
    v_cvt_pk_bf16_f32 v104, v82, -v83
    v_cvt_pk_bf16_f32 v108, v86, -v87
    v_mul_f32 v84, v82, v64
    v_mul_f32 v88, v86, v64
    v_mul_f32 v85, v82, v65
    v_mul_f32 v89, v86, v65
    v_fma_f32 v84, -v83, v65, v84
    v_fma_f32 v88, -v87, v65, v88
    v_fma_f32 v85, v83, v64, v85
    v_fma_f32 v89, v87, v64, v89
    v_cvt_pk_bf16_f32 v105, v84, -v85
    v_cvt_pk_bf16_f32 v109, v88, -v89
    ds_write2_b32 v9, v104, v105 offset0:8 offset1:12
    ds_write2_b32 v9, v108, v109 offset0:24 offset1:28
    v_mul_f32 v82, v84, v64
    v_mul_f32 v83, v84, v65
    v_fma_f32 v82, -v85, v65, v82
    v_fma_f32 v83, v85, v64, v83
    v_cvt_pk_bf16_f32 v102, v82, -v83
    v_mul_f32 v84, v82, v64
    v_mul_f32 v85, v82, v65
    v_fma_f32 v84, -v83, v65, v84
    v_fma_f32 v85, v83, v64, v85
    v_cvt_pk_bf16_f32 v103, v84, -v85
    ds_write2_b32 v9, v102, v103 offset0:32 offset1:36
    v_mul_f32 v82, v84, v64
    v_mul_f32 v83, v84, v65
    v_fma_f32 v82, -v85, v65, v82
    v_fma_f32 v83, v85, v64, v83
    v_cvt_pk_bf16_f32 v104, v82, -v83
    v_mul_f32 v84, v82, v64
    v_mul_f32 v85, v82, v65
    v_fma_f32 v84, -v83, v65, v84
    v_fma_f32 v85, v83, v64, v85
    v_cvt_pk_bf16_f32 v105, v84, -v85
    ds_write2_b32 v9, v104, v105 offset0:40 offset1:44
    v_mul_f32 v82, v84, v64
    v_mul_f32 v83, v84, v65
    v_fma_f32 v82, -v85, v65, v82
    v_fma_f32 v83, v85, v64, v83
    v_cvt_pk_bf16_f32 v102, v82, -v83
    v_mul_f32 v84, v82, v64
    v_mul_f32 v85, v82, v65
    v_fma_f32 v84, -v83, v65, v84
    v_fma_f32 v85, v83, v64, v85
    v_cvt_pk_bf16_f32 v103, v84, -v85
    ds_write2_b32 v9, v102, v103 offset0:48 offset1:52
    v_mul_f32 v82, v84, v64
    v_mul_f32 v83, v84, v65
    v_fma_f32 v82, -v85, v65, v82
    v_fma_f32 v83, v85, v64, v83
    v_cvt_pk_bf16_f32 v104, v82, -v83
    v_mul_f32 v84, v82, v64
    v_mul_f32 v85, v82, v65
    v_fma_f32 v84, -v83, v65, v84
    v_fma_f32 v85, v83, v64, v85
    v_cvt_pk_bf16_f32 v105, v84, -v85
    ds_write2_b32 v9, v104, v105 offset0:56 offset1:60
    ds_read_b128 v[152:155], v11 offset:4352
    ds_read_b128 v[156:159], v11 offset:5440
    ds_read_b128 v[160:163], v11 offset:6528
    ds_read_b128 v[164:167], v11 offset:7616
    v_mul_f32 v90, v84, v64
    v_mul_f32 v91, v84, v65
    v_fma_f32 v90, -v85, v65, v90
    v_fma_f32 v91, v85, v64, v91
    s_waitcnt lgkmcnt(12)
    v_mfma_f32_16x16x32_bf16 v[168:171], v[136:139], v[120:123], v[168:171]
    ds_write2_b32 v9, v110, v111 offset0:0 offset1:4
    v_mfma_f32_16x16x32_bf16 v[168:171], v[140:143], v[124:127], v[168:171]
    ds_write2_b32 v9, v112, v113 offset0:8 offset1:12
    v_mfma_f32_16x16x32_bf16 v[168:171], v[144:147], v[128:131], v[168:171]
    ds_write2_b32 v9, v114, v115 offset0:16 offset1:20
    v_mfma_f32_16x16x32_bf16 v[168:171], v[148:151], v[132:135], v[168:171]
    ds_write2_b32 v9, v116, v117 offset0:24 offset1:28
    v_cvt_pk_bf16_f32 v102, v90, -v91
    ds_write_b32 v9, v102 offset:128
    ds_read_b128 v[184:187], v11 offset:4352
    ds_read_b128 v[188:191], v11 offset:5440
    ds_read_b128 v[192:195], v11 offset:6528
    ds_read_b128 v[196:199], v11 offset:7616
    s_waitcnt lgkmcnt(0)
    v_mfma_f32_16x16x32_bf16 v[172:175], v[152:155], v[120:123], v[172:175]
    v_mfma_f32_16x16x32_bf16 v[172:175], v[156:159], v[124:127], v[172:175]
    v_mfma_f32_16x16x32_bf16 v[172:175], v[160:163], v[128:131], v[172:175]
    v_mfma_f32_16x16x32_bf16 v[172:175], v[164:167], v[132:135], v[172:175]
    v_mfma_f32_16x16x32_bf16 v[176:179], v[184:187], v[120:123], v[176:179]
    v_mfma_f32_16x16x32_bf16 v[176:179], v[188:191], v[124:127], v[176:179]
    v_mfma_f32_16x16x32_bf16 v[176:179], v[192:195], v[128:131], v[176:179]
    v_mfma_f32_16x16x32_bf16 v[176:179], v[196:199], v[132:135], v[176:179]
    s_mov_b64 exec, 1
    v_add_f32 v168, v168, v57
    s_mov_b64 exec, -1
    v_cvt_pk_bf16_f32 v42, v168, v169
    v_cvt_pk_bf16_f32 v43, v170, v171
    v_cvt_pk_bf16_f32 v29, v169, v170
    v_cvt_pk_bf16_f32 v20, v172, v172
    v_cvt_pk_bf16_f32 v21, v173, v173
    v_cvt_pk_bf16_f32 v22, v174, v174
    v_cvt_pk_bf16_f32 v23, v175, v175
    ds_write2_b32 v12, v20, v20 offset0:0 offset1:1
    ds_write2_b32 v13, v20, v20 offset0:0 offset1:1
    ds_write2_b32 v17, v20, v20 offset0:0 offset1:1
    ds_write2_b32 v18, v20, v20 offset0:0 offset1:1
    ds_write2_b32 v12, v21, v21 offset0:64 offset1:65
    ds_write2_b32 v13, v21, v21 offset0:64 offset1:65
    ds_write2_b32 v17, v21, v21 offset0:64 offset1:65
    ds_write2_b32 v18, v21, v21 offset0:64 offset1:65
    ds_write2_b32 v12, v22, v22 offset0:128 offset1:129
    ds_write2_b32 v13, v22, v22 offset0:128 offset1:129
    ds_write2_b32 v17, v22, v22 offset0:128 offset1:129
    ds_write2_b32 v18, v22, v22 offset0:128 offset1:129
    ds_write2_b32 v12, v23, v23 offset0:192 offset1:193
    ds_write2_b32 v13, v23, v23 offset0:192 offset1:193
    ds_write2_b32 v17, v23, v23 offset0:192 offset1:193
    ds_write2_b32 v18, v23, v23 offset0:192 offset1:193
    v_cvt_pk_bf16_f32 v24, v176, v176
    v_cvt_pk_bf16_f32 v25, v176, v177
    v_cvt_pk_bf16_f32 v26, v178, v178
    v_cvt_pk_bf16_f32 v27, v178, v179
    v_cvt_pk_bf16_f32 v28, v177, v178
    ds_write_b16 v14, v20 offset:0
    ds_write_b16 v16, v20 offset:0
    ds_write_b16 v14, v21 offset:256
    ds_write_b16 v15, v21 offset:256
    ds_write_b16 v14, v22 offset:512
    ds_write_b16 v15, v22 offset:512
    ds_write_b16 v14, v23 offset:768
    ds_write_b16 v15, v23 offset:768
    s_mov_b32 exec_hi, 0
    ds_write2_b32 v30, v24, v28 offset0:0 offset1:1
    ds_write_b32 v30, v26 offset:8
    ds_write_b16_d16_hi v30, v27 offset:12
    ds_write_b16 v32, v24
    ds_write2_b32 v31, v24, v25 offset0:0 offset1:1
    ds_write2_b32 v31, v26, v27 offset0:2 offset1:3
    s_mov_b32 exec_lo, 0
    s_mov_b32 exec_hi, 1
    ds_write2_b32 v33, v24, v24 offset0:0 offset1:1
    ds_write2_b32 v35, v24, v24 offset0:0 offset1:1
    ds_write_b16 v34, v24
    s_mov_b64 exec, 15
    ds_write_b64 v38, v[40:41]
    ds_write_b64 v38, v[40:41] offset:4160
    s_lshr_b64 exec, -1, 4
    ds_write_b64 v38, v[40:41] offset:8320
    s_mov_b64 exec, -1
    ds_write_b64 v36, v[42:43]
    ds_write_b16 v37, v42
    ds_write_b32 v36, v29 offset:4160
    ds_write_b16_d16_hi v37, v43 offset:6
    v_mov_b32 v2, 161680
    s_mov_b32 s61, 0
fused_cn:
    ds_read_b128 v[4:7], v2
    s_add_u32 s61, s61, 1
    s_waitcnt lgkmcnt(0)
    v_readfirstlane_b32 s60, v4
    s_cmp_gt_u32 s61, 0x200000
    s_cbranch_scc1 fused_cn_d
    s_cmp_lg_u32 s60, 0
    s_cbranch_scc1 fused_cn_d
    s_sleep 1
    s_branch fused_cn
fused_cn_d:
    s_mov_b32 s96, s60
    v_mov_b32 v2, 161616
    s_mov_b32 s61, 0
fused_uw:
    ds_read_b128 v[4:7], v2
    s_add_u32 s61, s61, 1
    s_waitcnt lgkmcnt(0)
    v_readfirstlane_b32 s60, v4
    s_cmp_gt_u32 s61, 0x200000
    s_cbranch_scc1 fused_uw_d
    s_cmp_lg_u32 s60, 0
    s_cbranch_scc1 fused_uw_d
    s_sleep 1
    s_branch fused_uw
fused_uw_d:
    s_setprio 1
    ds_read_b128 v[124:127], v224 offset:0
    ds_read2_b32 v[92:93], v220 offset0:112 offset1:113
    ds_read2_b32 v[94:95], v220 offset0:114 offset1:115
    ds_read_b128 v[128:131], v224 offset:512
    ds_read2_b32 v[96:97], v220 offset0:240 offset1:241
    ds_read2_b32 v[98:99], v220 offset0:242 offset1:243
    ds_read_b128 v[132:135], v224 offset:1024
    ds_read2_b32 v[100:101], v221 offset0:112 offset1:113
    ds_read2_b32 v[102:103], v221 offset0:114 offset1:115
    ds_read_b128 v[136:139], v224 offset:1536
    ds_read2_b32 v[104:105], v221 offset0:240 offset1:241
    ds_read2_b32 v[106:107], v221 offset0:242 offset1:243
    ds_read_b128 v[140:143], v224 offset:2048
    s_waitcnt lgkmcnt(3)
    ds_read2_b32 v[108:109], v222 offset0:112 offset1:113
    ds_read2_b32 v[110:111], v222 offset0:114 offset1:115
    ds_read_b128 v[144:147], v224 offset:2560
    ds_read2_b32 v[112:113], v222 offset0:240 offset1:241
    ds_read2_b32 v[114:115], v222 offset0:242 offset1:243
    ds_read_b128 v[148:151], v224 offset:3072
    ds_read2_b32 v[116:117], v223 offset0:112 offset1:113
    ds_read2_b32 v[118:119], v223 offset0:114 offset1:115
    ds_read_b128 v[152:155], v224 offset:3584
    ds_read2_b32 v[120:121], v223 offset0:240 offset1:241
    ds_read2_b32 v[122:123], v223 offset0:242 offset1:243
    s_waitcnt lgkmcnt(0)
    v_mfma_f32_16x16x32_bf16 v[60:63], v[92:95], v[124:127], 0
    ds_read_b128 v[188:191], v224 offset:64
    v_mfma_f32_16x16x32_bf16 v[64:67], v[92:95], v[128:131], 0
    ds_read2_b32 v[156:157], v220 offset0:96 offset1:97
    v_mfma_f32_16x16x32_bf16 v[64:67], v[96:99], v[124:127], v[64:67]
    ds_read2_b32 v[158:159], v220 offset0:98 offset1:99
    v_mfma_f32_16x16x32_bf16 v[68:71], v[96:99], v[128:131], 0
    ds_read_b128 v[192:195], v224 offset:576
    v_mfma_f32_16x16x32_bf16 v[68:71], v[92:95], v[132:135], v[68:71]
    v_mfma_f32_16x16x32_bf16 v[72:75], v[96:99], v[132:135], 0
    ds_read2_b32 v[160:161], v220 offset0:224 offset1:225
    v_mfma_f32_16x16x32_bf16 v[68:71], v[100:103], v[124:127], v[68:71]
    ds_read2_b32 v[162:163], v220 offset0:226 offset1:227
    v_mfma_f32_16x16x32_bf16 v[72:75], v[100:103], v[128:131], v[72:75]
    ds_read_b128 v[196:199], v224 offset:1088
    v_mfma_f32_16x16x32_bf16 v[76:79], v[100:103], v[132:135], 0
    ds_read2_b32 v[164:165], v221 offset0:96 offset1:97
    v_mfma_f32_16x16x32_bf16 v[72:75], v[92:95], v[136:139], v[72:75]
    v_mfma_f32_16x16x32_bf16 v[76:79], v[96:99], v[136:139], v[76:79]
    ds_read2_b32 v[166:167], v221 offset0:98 offset1:99
    v_mfma_f32_16x16x32_bf16 v[80:83], v[100:103], v[136:139], 0
    ds_read_b128 v[200:203], v224 offset:1600
    v_mfma_f32_16x16x32_bf16 v[72:75], v[104:107], v[124:127], v[72:75]
    ds_read2_b32 v[168:169], v221 offset0:224 offset1:225
    v_mfma_f32_16x16x32_bf16 v[76:79], v[104:107], v[128:131], v[76:79]
    ds_read2_b32 v[170:171], v221 offset0:226 offset1:227
    v_mfma_f32_16x16x32_bf16 v[80:83], v[104:107], v[132:135], v[80:83]
    v_mfma_f32_16x16x32_bf16 v[84:87], v[104:107], v[136:139], 0
    ds_read_b128 v[204:207], v224 offset:2112
    v_mfma_f32_16x16x32_bf16 v[76:79], v[92:95], v[140:143], v[76:79]
    ds_read2_b32 v[172:173], v222 offset0:96 offset1:97
    v_mfma_f32_16x16x32_bf16 v[80:83], v[96:99], v[140:143], v[80:83]
    ds_read2_b32 v[174:175], v222 offset0:98 offset1:99
    v_mfma_f32_16x16x32_bf16 v[84:87], v[100:103], v[140:143], v[84:87]
    ds_read_b128 v[208:211], v224 offset:2624
    v_mfma_f32_16x16x32_bf16 v[88:91], v[104:107], v[140:143], 0
    v_mfma_f32_16x16x32_bf16 v[76:79], v[108:111], v[124:127], v[76:79]
    ds_read2_b32 v[176:177], v222 offset0:224 offset1:225
    v_mfma_f32_16x16x32_bf16 v[80:83], v[108:111], v[128:131], v[80:83]
    ds_read2_b32 v[178:179], v222 offset0:226 offset1:227
    v_mfma_f32_16x16x32_bf16 v[84:87], v[108:111], v[132:135], v[84:87]
    ds_read_b128 v[212:215], v224 offset:3136
    v_mfma_f32_16x16x32_bf16 v[88:91], v[108:111], v[136:139], v[88:91]
    ds_read2_b32 v[180:181], v223 offset0:96 offset1:97
    v_mfma_f32_16x16x32_bf16 v[80:83], v[92:95], v[144:147], v[80:83]
    v_mfma_f32_16x16x32_bf16 v[84:87], v[96:99], v[144:147], v[84:87]
    ds_read2_b32 v[182:183], v223 offset0:98 offset1:99
    v_mfma_f32_16x16x32_bf16 v[88:91], v[100:103], v[144:147], v[88:91]
    ds_read_b128 v[216:219], v224 offset:3648
    v_mfma_f32_16x16x32_bf16 v[80:83], v[112:115], v[124:127], v[80:83]
    ds_read2_b32 v[184:185], v223 offset0:224 offset1:225
    v_mfma_f32_16x16x32_bf16 v[84:87], v[112:115], v[128:131], v[84:87]
    ds_read2_b32 v[186:187], v223 offset0:226 offset1:227
    v_mfma_f32_16x16x32_bf16 v[88:91], v[112:115], v[132:135], v[88:91]
    v_mfma_f32_16x16x32_bf16 v[84:87], v[92:95], v[148:151], v[84:87]
    v_mfma_f32_16x16x32_bf16 v[88:91], v[96:99], v[148:151], v[88:91]
    v_mfma_f32_16x16x32_bf16 v[84:87], v[116:119], v[124:127], v[84:87]
    v_mfma_f32_16x16x32_bf16 v[88:91], v[116:119], v[128:131], v[88:91]
    v_mfma_f32_16x16x32_bf16 v[88:91], v[92:95], v[152:155], v[88:91]
    v_mfma_f32_16x16x32_bf16 v[88:91], v[120:123], v[124:127], v[88:91]
    s_waitcnt lgkmcnt(0)
    v_mfma_f32_16x16x32_bf16 v[60:63], v[156:159], v[188:191], v[60:63]
    ds_read_b128 v[124:127], v224 offset:128
    v_mfma_f32_16x16x32_bf16 v[64:67], v[156:159], v[192:195], v[64:67]
    ds_read2_b32 v[92:93], v220 offset0:80 offset1:81
    v_mfma_f32_16x16x32_bf16 v[64:67], v[160:163], v[188:191], v[64:67]
    ds_read2_b32 v[94:95], v220 offset0:82 offset1:83
    v_mfma_f32_16x16x32_bf16 v[68:71], v[160:163], v[192:195], v[68:71]
    ds_read_b128 v[128:131], v224 offset:640
    v_mfma_f32_16x16x32_bf16 v[68:71], v[156:159], v[196:199], v[68:71]
    v_mfma_f32_16x16x32_bf16 v[72:75], v[160:163], v[196:199], v[72:75]
    ds_read2_b32 v[96:97], v220 offset0:208 offset1:209
    v_mfma_f32_16x16x32_bf16 v[68:71], v[164:167], v[188:191], v[68:71]
    ds_read2_b32 v[98:99], v220 offset0:210 offset1:211
    v_mfma_f32_16x16x32_bf16 v[72:75], v[164:167], v[192:195], v[72:75]
    ds_read_b128 v[132:135], v224 offset:1152
    v_mfma_f32_16x16x32_bf16 v[76:79], v[164:167], v[196:199], v[76:79]
    ds_read2_b32 v[100:101], v221 offset0:80 offset1:81
    v_mfma_f32_16x16x32_bf16 v[72:75], v[156:159], v[200:203], v[72:75]
    v_mfma_f32_16x16x32_bf16 v[76:79], v[160:163], v[200:203], v[76:79]
    ds_read2_b32 v[102:103], v221 offset0:82 offset1:83
    v_mfma_f32_16x16x32_bf16 v[80:83], v[164:167], v[200:203], v[80:83]
    ds_read_b128 v[136:139], v224 offset:1664
    v_mfma_f32_16x16x32_bf16 v[72:75], v[168:171], v[188:191], v[72:75]
    ds_read2_b32 v[104:105], v221 offset0:208 offset1:209
    v_mfma_f32_16x16x32_bf16 v[76:79], v[168:171], v[192:195], v[76:79]
    ds_read2_b32 v[106:107], v221 offset0:210 offset1:211
    v_mfma_f32_16x16x32_bf16 v[80:83], v[168:171], v[196:199], v[80:83]
    v_mfma_f32_16x16x32_bf16 v[84:87], v[168:171], v[200:203], v[84:87]
    ds_read_b128 v[140:143], v224 offset:2176
    v_mfma_f32_16x16x32_bf16 v[76:79], v[156:159], v[204:207], v[76:79]
    ds_read2_b32 v[108:109], v222 offset0:80 offset1:81
    v_mfma_f32_16x16x32_bf16 v[80:83], v[160:163], v[204:207], v[80:83]
    ds_read2_b32 v[110:111], v222 offset0:82 offset1:83
    v_mfma_f32_16x16x32_bf16 v[84:87], v[164:167], v[204:207], v[84:87]
    ds_read_b128 v[144:147], v224 offset:2688
    v_mfma_f32_16x16x32_bf16 v[88:91], v[168:171], v[204:207], v[88:91]
    v_mfma_f32_16x16x32_bf16 v[76:79], v[172:175], v[188:191], v[76:79]
    ds_read2_b32 v[112:113], v222 offset0:208 offset1:209
    v_mfma_f32_16x16x32_bf16 v[80:83], v[172:175], v[192:195], v[80:83]
    ds_read2_b32 v[114:115], v222 offset0:210 offset1:211
    v_mfma_f32_16x16x32_bf16 v[84:87], v[172:175], v[196:199], v[84:87]
    ds_read_b128 v[148:151], v224 offset:3200
    v_mfma_f32_16x16x32_bf16 v[88:91], v[172:175], v[200:203], v[88:91]
    ds_read2_b32 v[116:117], v223 offset0:80 offset1:81
    v_mfma_f32_16x16x32_bf16 v[80:83], v[156:159], v[208:211], v[80:83]
    v_mfma_f32_16x16x32_bf16 v[84:87], v[160:163], v[208:211], v[84:87]
    ds_read2_b32 v[118:119], v223 offset0:82 offset1:83
    v_mfma_f32_16x16x32_bf16 v[88:91], v[164:167], v[208:211], v[88:91]
    ds_read_b128 v[152:155], v224 offset:3712
    v_mfma_f32_16x16x32_bf16 v[80:83], v[176:179], v[188:191], v[80:83]
    ds_read2_b32 v[120:121], v223 offset0:208 offset1:209
    v_mfma_f32_16x16x32_bf16 v[84:87], v[176:179], v[192:195], v[84:87]
    ds_read2_b32 v[122:123], v223 offset0:210 offset1:211
    v_mfma_f32_16x16x32_bf16 v[88:91], v[176:179], v[196:199], v[88:91]
    v_mfma_f32_16x16x32_bf16 v[84:87], v[156:159], v[212:215], v[84:87]
    v_mfma_f32_16x16x32_bf16 v[88:91], v[160:163], v[212:215], v[88:91]
    v_mfma_f32_16x16x32_bf16 v[84:87], v[180:183], v[188:191], v[84:87]
    v_mfma_f32_16x16x32_bf16 v[88:91], v[180:183], v[192:195], v[88:91]
    v_mfma_f32_16x16x32_bf16 v[88:91], v[156:159], v[216:219], v[88:91]
    v_mfma_f32_16x16x32_bf16 v[88:91], v[184:187], v[188:191], v[88:91]
    s_waitcnt lgkmcnt(0)
    v_mfma_f32_16x16x32_bf16 v[60:63], v[92:95], v[124:127], v[60:63]
    ds_read_b128 v[188:191], v224 offset:192
    v_mfma_f32_16x16x32_bf16 v[64:67], v[92:95], v[128:131], v[64:67]
    ds_read2_b32 v[156:157], v220 offset0:64 offset1:65
    v_mfma_f32_16x16x32_bf16 v[64:67], v[96:99], v[124:127], v[64:67]
    ds_read2_b32 v[158:159], v220 offset0:66 offset1:67
    v_mfma_f32_16x16x32_bf16 v[68:71], v[96:99], v[128:131], v[68:71]
    ds_read_b128 v[192:195], v224 offset:704
    v_mfma_f32_16x16x32_bf16 v[68:71], v[92:95], v[132:135], v[68:71]
    v_mfma_f32_16x16x32_bf16 v[72:75], v[96:99], v[132:135], v[72:75]
    ds_read2_b32 v[160:161], v220 offset0:192 offset1:193
    v_mfma_f32_16x16x32_bf16 v[68:71], v[100:103], v[124:127], v[68:71]
    ds_read2_b32 v[162:163], v220 offset0:194 offset1:195
    v_mfma_f32_16x16x32_bf16 v[72:75], v[100:103], v[128:131], v[72:75]
    ds_read_b128 v[196:199], v224 offset:1216
    v_mfma_f32_16x16x32_bf16 v[76:79], v[100:103], v[132:135], v[76:79]
    ds_read2_b32 v[164:165], v221 offset0:64 offset1:65
    v_mfma_f32_16x16x32_bf16 v[72:75], v[92:95], v[136:139], v[72:75]
    v_mfma_f32_16x16x32_bf16 v[76:79], v[96:99], v[136:139], v[76:79]
    ds_read2_b32 v[166:167], v221 offset0:66 offset1:67
    v_mfma_f32_16x16x32_bf16 v[80:83], v[100:103], v[136:139], v[80:83]
    ds_read_b128 v[200:203], v224 offset:1728
    v_mfma_f32_16x16x32_bf16 v[72:75], v[104:107], v[124:127], v[72:75]
    ds_read2_b32 v[168:169], v221 offset0:192 offset1:193
    v_mfma_f32_16x16x32_bf16 v[76:79], v[104:107], v[128:131], v[76:79]
    ds_read2_b32 v[170:171], v221 offset0:194 offset1:195
    v_mfma_f32_16x16x32_bf16 v[80:83], v[104:107], v[132:135], v[80:83]
    v_mfma_f32_16x16x32_bf16 v[84:87], v[104:107], v[136:139], v[84:87]
    ds_read_b128 v[204:207], v224 offset:2240
    v_mfma_f32_16x16x32_bf16 v[76:79], v[92:95], v[140:143], v[76:79]
    ds_read2_b32 v[172:173], v222 offset0:64 offset1:65
    v_mfma_f32_16x16x32_bf16 v[80:83], v[96:99], v[140:143], v[80:83]
    ds_read2_b32 v[174:175], v222 offset0:66 offset1:67
    v_mfma_f32_16x16x32_bf16 v[84:87], v[100:103], v[140:143], v[84:87]
    ds_read_b128 v[208:211], v224 offset:2752
    v_mfma_f32_16x16x32_bf16 v[88:91], v[104:107], v[140:143], v[88:91]
    v_mfma_f32_16x16x32_bf16 v[76:79], v[108:111], v[124:127], v[76:79]
    ds_read2_b32 v[176:177], v222 offset0:192 offset1:193
    v_mfma_f32_16x16x32_bf16 v[80:83], v[108:111], v[128:131], v[80:83]
    ds_read2_b32 v[178:179], v222 offset0:194 offset1:195
    v_mfma_f32_16x16x32_bf16 v[84:87], v[108:111], v[132:135], v[84:87]
    ds_read_b128 v[212:215], v224 offset:3264
    v_mfma_f32_16x16x32_bf16 v[88:91], v[108:111], v[136:139], v[88:91]
    ds_read2_b32 v[180:181], v223 offset0:64 offset1:65
    v_mfma_f32_16x16x32_bf16 v[80:83], v[92:95], v[144:147], v[80:83]
    v_mfma_f32_16x16x32_bf16 v[84:87], v[96:99], v[144:147], v[84:87]
    ds_read2_b32 v[182:183], v223 offset0:66 offset1:67
    v_mfma_f32_16x16x32_bf16 v[88:91], v[100:103], v[144:147], v[88:91]
    ds_read_b128 v[216:219], v224 offset:3776
    v_mfma_f32_16x16x32_bf16 v[80:83], v[112:115], v[124:127], v[80:83]
    ds_read2_b32 v[184:185], v223 offset0:192 offset1:193
    v_mfma_f32_16x16x32_bf16 v[84:87], v[112:115], v[128:131], v[84:87]
    ds_read2_b32 v[186:187], v223 offset0:194 offset1:195
    v_mfma_f32_16x16x32_bf16 v[88:91], v[112:115], v[132:135], v[88:91]
    v_mfma_f32_16x16x32_bf16 v[84:87], v[92:95], v[148:151], v[84:87]
    v_mfma_f32_16x16x32_bf16 v[88:91], v[96:99], v[148:151], v[88:91]
    v_mfma_f32_16x16x32_bf16 v[84:87], v[116:119], v[124:127], v[84:87]
    v_mfma_f32_16x16x32_bf16 v[88:91], v[116:119], v[128:131], v[88:91]
    v_mfma_f32_16x16x32_bf16 v[88:91], v[92:95], v[152:155], v[88:91]
    v_mfma_f32_16x16x32_bf16 v[88:91], v[120:123], v[124:127], v[88:91]
    s_waitcnt lgkmcnt(0)
    v_mfma_f32_16x16x32_bf16 v[60:63], v[156:159], v[188:191], v[60:63]
    ds_read_b128 v[124:127], v224 offset:256
    v_mfma_f32_16x16x32_bf16 v[64:67], v[156:159], v[192:195], v[64:67]
    ds_read2_b32 v[92:93], v220 offset0:48 offset1:49
    v_mfma_f32_16x16x32_bf16 v[64:67], v[160:163], v[188:191], v[64:67]
    ds_read2_b32 v[94:95], v220 offset0:50 offset1:51
    v_mfma_f32_16x16x32_bf16 v[68:71], v[160:163], v[192:195], v[68:71]
    ds_read_b128 v[128:131], v224 offset:768
    v_mfma_f32_16x16x32_bf16 v[68:71], v[156:159], v[196:199], v[68:71]
    v_mfma_f32_16x16x32_bf16 v[72:75], v[160:163], v[196:199], v[72:75]
    ds_read2_b32 v[96:97], v220 offset0:176 offset1:177
    v_mfma_f32_16x16x32_bf16 v[68:71], v[164:167], v[188:191], v[68:71]
    ds_read2_b32 v[98:99], v220 offset0:178 offset1:179
    v_mfma_f32_16x16x32_bf16 v[72:75], v[164:167], v[192:195], v[72:75]
    ds_read_b128 v[132:135], v224 offset:1280
    v_mfma_f32_16x16x32_bf16 v[76:79], v[164:167], v[196:199], v[76:79]
    ds_read2_b32 v[100:101], v221 offset0:48 offset1:49
    v_mfma_f32_16x16x32_bf16 v[72:75], v[156:159], v[200:203], v[72:75]
    v_mfma_f32_16x16x32_bf16 v[76:79], v[160:163], v[200:203], v[76:79]
    ds_read2_b32 v[102:103], v221 offset0:50 offset1:51
    v_mfma_f32_16x16x32_bf16 v[80:83], v[164:167], v[200:203], v[80:83]
    ds_read_b128 v[136:139], v224 offset:1792
    v_mfma_f32_16x16x32_bf16 v[72:75], v[168:171], v[188:191], v[72:75]
    ds_read2_b32 v[104:105], v221 offset0:176 offset1:177
    v_mfma_f32_16x16x32_bf16 v[76:79], v[168:171], v[192:195], v[76:79]
    ds_read2_b32 v[106:107], v221 offset0:178 offset1:179
    v_mfma_f32_16x16x32_bf16 v[80:83], v[168:171], v[196:199], v[80:83]
    v_mfma_f32_16x16x32_bf16 v[84:87], v[168:171], v[200:203], v[84:87]
    ds_read_b128 v[140:143], v224 offset:2304
    v_mfma_f32_16x16x32_bf16 v[76:79], v[156:159], v[204:207], v[76:79]
    ds_read2_b32 v[108:109], v222 offset0:48 offset1:49
    v_mfma_f32_16x16x32_bf16 v[80:83], v[160:163], v[204:207], v[80:83]
    ds_read2_b32 v[110:111], v222 offset0:50 offset1:51
    v_mfma_f32_16x16x32_bf16 v[84:87], v[164:167], v[204:207], v[84:87]
    ds_read_b128 v[144:147], v224 offset:2816
    v_mfma_f32_16x16x32_bf16 v[88:91], v[168:171], v[204:207], v[88:91]
    v_mfma_f32_16x16x32_bf16 v[76:79], v[172:175], v[188:191], v[76:79]
    ds_read2_b32 v[112:113], v222 offset0:176 offset1:177
    v_mfma_f32_16x16x32_bf16 v[80:83], v[172:175], v[192:195], v[80:83]
    ds_read2_b32 v[114:115], v222 offset0:178 offset1:179
    v_mfma_f32_16x16x32_bf16 v[84:87], v[172:175], v[196:199], v[84:87]
    ds_read_b128 v[148:151], v224 offset:3328
    v_mfma_f32_16x16x32_bf16 v[88:91], v[172:175], v[200:203], v[88:91]
    ds_read2_b32 v[116:117], v223 offset0:48 offset1:49
    v_mfma_f32_16x16x32_bf16 v[80:83], v[156:159], v[208:211], v[80:83]
    v_mfma_f32_16x16x32_bf16 v[84:87], v[160:163], v[208:211], v[84:87]
    ds_read2_b32 v[118:119], v223 offset0:50 offset1:51
    v_mfma_f32_16x16x32_bf16 v[88:91], v[164:167], v[208:211], v[88:91]
    ds_read_b128 v[152:155], v224 offset:3840
    v_mfma_f32_16x16x32_bf16 v[80:83], v[176:179], v[188:191], v[80:83]
    ds_read2_b32 v[120:121], v223 offset0:176 offset1:177
    v_mfma_f32_16x16x32_bf16 v[84:87], v[176:179], v[192:195], v[84:87]
    ds_read2_b32 v[122:123], v223 offset0:178 offset1:179
    v_mfma_f32_16x16x32_bf16 v[88:91], v[176:179], v[196:199], v[88:91]
    v_mfma_f32_16x16x32_bf16 v[84:87], v[156:159], v[212:215], v[84:87]
    v_mfma_f32_16x16x32_bf16 v[88:91], v[160:163], v[212:215], v[88:91]
    v_mfma_f32_16x16x32_bf16 v[84:87], v[180:183], v[188:191], v[84:87]
    v_mfma_f32_16x16x32_bf16 v[88:91], v[180:183], v[192:195], v[88:91]
    v_mfma_f32_16x16x32_bf16 v[88:91], v[156:159], v[216:219], v[88:91]
    v_mfma_f32_16x16x32_bf16 v[88:91], v[184:187], v[188:191], v[88:91]
    s_waitcnt lgkmcnt(0)
    v_mfma_f32_16x16x32_bf16 v[60:63], v[92:95], v[124:127], v[60:63]
    ds_read_b128 v[188:191], v224 offset:320
    v_mfma_f32_16x16x32_bf16 v[64:67], v[92:95], v[128:131], v[64:67]
    ds_read2_b32 v[156:157], v220 offset0:32 offset1:33
    v_mfma_f32_16x16x32_bf16 v[64:67], v[96:99], v[124:127], v[64:67]
    ds_read2_b32 v[158:159], v220 offset0:34 offset1:35
    v_mfma_f32_16x16x32_bf16 v[68:71], v[96:99], v[128:131], v[68:71]
    ds_read_b128 v[192:195], v224 offset:832
    v_mfma_f32_16x16x32_bf16 v[68:71], v[92:95], v[132:135], v[68:71]
    v_mfma_f32_16x16x32_bf16 v[72:75], v[96:99], v[132:135], v[72:75]
    ds_read2_b32 v[160:161], v220 offset0:160 offset1:161
    v_mfma_f32_16x16x32_bf16 v[68:71], v[100:103], v[124:127], v[68:71]
    ds_read2_b32 v[162:163], v220 offset0:162 offset1:163
    v_mfma_f32_16x16x32_bf16 v[72:75], v[100:103], v[128:131], v[72:75]
    ds_read_b128 v[196:199], v224 offset:1344
    v_mfma_f32_16x16x32_bf16 v[76:79], v[100:103], v[132:135], v[76:79]
    ds_read2_b32 v[164:165], v221 offset0:32 offset1:33
    v_mfma_f32_16x16x32_bf16 v[72:75], v[92:95], v[136:139], v[72:75]
    v_mfma_f32_16x16x32_bf16 v[76:79], v[96:99], v[136:139], v[76:79]
    ds_read2_b32 v[166:167], v221 offset0:34 offset1:35
    v_mfma_f32_16x16x32_bf16 v[80:83], v[100:103], v[136:139], v[80:83]
    ds_read_b128 v[200:203], v224 offset:1856
    v_mfma_f32_16x16x32_bf16 v[72:75], v[104:107], v[124:127], v[72:75]
    ds_read2_b32 v[168:169], v221 offset0:160 offset1:161
    v_mfma_f32_16x16x32_bf16 v[76:79], v[104:107], v[128:131], v[76:79]
    ds_read2_b32 v[170:171], v221 offset0:162 offset1:163
    v_mfma_f32_16x16x32_bf16 v[80:83], v[104:107], v[132:135], v[80:83]
    v_mfma_f32_16x16x32_bf16 v[84:87], v[104:107], v[136:139], v[84:87]
    ds_read_b128 v[204:207], v224 offset:2368
    v_mfma_f32_16x16x32_bf16 v[76:79], v[92:95], v[140:143], v[76:79]
    ds_read2_b32 v[172:173], v222 offset0:32 offset1:33
    v_mfma_f32_16x16x32_bf16 v[80:83], v[96:99], v[140:143], v[80:83]
    ds_read2_b32 v[174:175], v222 offset0:34 offset1:35
    v_mfma_f32_16x16x32_bf16 v[84:87], v[100:103], v[140:143], v[84:87]
    ds_read_b128 v[208:211], v224 offset:2880
    v_mfma_f32_16x16x32_bf16 v[88:91], v[104:107], v[140:143], v[88:91]
    v_mfma_f32_16x16x32_bf16 v[76:79], v[108:111], v[124:127], v[76:79]
    ds_read2_b32 v[176:177], v222 offset0:160 offset1:161
    v_mfma_f32_16x16x32_bf16 v[80:83], v[108:111], v[128:131], v[80:83]
    ds_read2_b32 v[178:179], v222 offset0:162 offset1:163
    v_mfma_f32_16x16x32_bf16 v[84:87], v[108:111], v[132:135], v[84:87]
    ds_read_b128 v[212:215], v224 offset:3392
    v_mfma_f32_16x16x32_bf16 v[88:91], v[108:111], v[136:139], v[88:91]
    ds_read2_b32 v[180:181], v223 offset0:32 offset1:33
    v_mfma_f32_16x16x32_bf16 v[80:83], v[92:95], v[144:147], v[80:83]
    v_mfma_f32_16x16x32_bf16 v[84:87], v[96:99], v[144:147], v[84:87]
    ds_read2_b32 v[182:183], v223 offset0:34 offset1:35
    v_mfma_f32_16x16x32_bf16 v[88:91], v[100:103], v[144:147], v[88:91]
    ds_read_b128 v[216:219], v224 offset:3904
    v_mfma_f32_16x16x32_bf16 v[80:83], v[112:115], v[124:127], v[80:83]
    ds_read2_b32 v[184:185], v223 offset0:160 offset1:161
    v_mfma_f32_16x16x32_bf16 v[84:87], v[112:115], v[128:131], v[84:87]
    ds_read2_b32 v[186:187], v223 offset0:162 offset1:163
    v_mfma_f32_16x16x32_bf16 v[88:91], v[112:115], v[132:135], v[88:91]
    v_mfma_f32_16x16x32_bf16 v[84:87], v[92:95], v[148:151], v[84:87]
    v_mfma_f32_16x16x32_bf16 v[88:91], v[96:99], v[148:151], v[88:91]
    v_mfma_f32_16x16x32_bf16 v[84:87], v[116:119], v[124:127], v[84:87]
    v_mfma_f32_16x16x32_bf16 v[88:91], v[116:119], v[128:131], v[88:91]
    v_mfma_f32_16x16x32_bf16 v[88:91], v[92:95], v[152:155], v[88:91]
    v_mfma_f32_16x16x32_bf16 v[88:91], v[120:123], v[124:127], v[88:91]
    s_waitcnt lgkmcnt(0)
    v_mfma_f32_16x16x32_bf16 v[60:63], v[156:159], v[188:191], v[60:63]
    ds_read_b128 v[124:127], v224 offset:384
    v_mfma_f32_16x16x32_bf16 v[64:67], v[156:159], v[192:195], v[64:67]
    ds_read2_b32 v[92:93], v220 offset0:16 offset1:17
    v_mfma_f32_16x16x32_bf16 v[64:67], v[160:163], v[188:191], v[64:67]
    ds_read2_b32 v[94:95], v220 offset0:18 offset1:19
    v_mfma_f32_16x16x32_bf16 v[68:71], v[160:163], v[192:195], v[68:71]
    ds_read_b128 v[128:131], v224 offset:896
    v_mfma_f32_16x16x32_bf16 v[68:71], v[156:159], v[196:199], v[68:71]
    v_mfma_f32_16x16x32_bf16 v[72:75], v[160:163], v[196:199], v[72:75]
    ds_read2_b32 v[96:97], v220 offset0:144 offset1:145
    v_mfma_f32_16x16x32_bf16 v[68:71], v[164:167], v[188:191], v[68:71]
    ds_read2_b32 v[98:99], v220 offset0:146 offset1:147
    v_mfma_f32_16x16x32_bf16 v[72:75], v[164:167], v[192:195], v[72:75]
    ds_read_b128 v[132:135], v224 offset:1408
    v_mfma_f32_16x16x32_bf16 v[76:79], v[164:167], v[196:199], v[76:79]
    ds_read2_b32 v[100:101], v221 offset0:16 offset1:17
    v_mfma_f32_16x16x32_bf16 v[72:75], v[156:159], v[200:203], v[72:75]
    v_mfma_f32_16x16x32_bf16 v[76:79], v[160:163], v[200:203], v[76:79]
    ds_read2_b32 v[102:103], v221 offset0:18 offset1:19
    v_mfma_f32_16x16x32_bf16 v[80:83], v[164:167], v[200:203], v[80:83]
    ds_read_b128 v[136:139], v224 offset:1920
    v_mfma_f32_16x16x32_bf16 v[72:75], v[168:171], v[188:191], v[72:75]
    ds_read2_b32 v[104:105], v221 offset0:144 offset1:145
    v_mfma_f32_16x16x32_bf16 v[76:79], v[168:171], v[192:195], v[76:79]
    ds_read2_b32 v[106:107], v221 offset0:146 offset1:147
    v_mfma_f32_16x16x32_bf16 v[80:83], v[168:171], v[196:199], v[80:83]
    v_mfma_f32_16x16x32_bf16 v[84:87], v[168:171], v[200:203], v[84:87]
    ds_read_b128 v[140:143], v224 offset:2432
    v_mfma_f32_16x16x32_bf16 v[76:79], v[156:159], v[204:207], v[76:79]
    ds_read2_b32 v[108:109], v222 offset0:16 offset1:17
    v_mfma_f32_16x16x32_bf16 v[80:83], v[160:163], v[204:207], v[80:83]
    ds_read2_b32 v[110:111], v222 offset0:18 offset1:19
    v_mfma_f32_16x16x32_bf16 v[84:87], v[164:167], v[204:207], v[84:87]
    ds_read_b128 v[144:147], v224 offset:2944
    v_mfma_f32_16x16x32_bf16 v[88:91], v[168:171], v[204:207], v[88:91]
    v_mfma_f32_16x16x32_bf16 v[76:79], v[172:175], v[188:191], v[76:79]
    ds_read2_b32 v[112:113], v222 offset0:144 offset1:145
    v_mfma_f32_16x16x32_bf16 v[80:83], v[172:175], v[192:195], v[80:83]
    ds_read2_b32 v[114:115], v222 offset0:146 offset1:147
    v_mfma_f32_16x16x32_bf16 v[84:87], v[172:175], v[196:199], v[84:87]
    ds_read_b128 v[148:151], v224 offset:3456
    v_mfma_f32_16x16x32_bf16 v[88:91], v[172:175], v[200:203], v[88:91]
    ds_read2_b32 v[116:117], v223 offset0:16 offset1:17
    v_mfma_f32_16x16x32_bf16 v[80:83], v[156:159], v[208:211], v[80:83]
    v_mfma_f32_16x16x32_bf16 v[84:87], v[160:163], v[208:211], v[84:87]
    ds_read2_b32 v[118:119], v223 offset0:18 offset1:19
    v_mfma_f32_16x16x32_bf16 v[88:91], v[164:167], v[208:211], v[88:91]
    ds_read_b128 v[152:155], v224 offset:3968
    v_mfma_f32_16x16x32_bf16 v[80:83], v[176:179], v[188:191], v[80:83]
    ds_read2_b32 v[120:121], v223 offset0:144 offset1:145
    v_mfma_f32_16x16x32_bf16 v[84:87], v[176:179], v[192:195], v[84:87]
    ds_read2_b32 v[122:123], v223 offset0:146 offset1:147
    v_mfma_f32_16x16x32_bf16 v[88:91], v[176:179], v[196:199], v[88:91]
    v_mfma_f32_16x16x32_bf16 v[84:87], v[156:159], v[212:215], v[84:87]
    v_mfma_f32_16x16x32_bf16 v[88:91], v[160:163], v[212:215], v[88:91]
    v_mfma_f32_16x16x32_bf16 v[84:87], v[180:183], v[188:191], v[84:87]
    v_mfma_f32_16x16x32_bf16 v[88:91], v[180:183], v[192:195], v[88:91]
    v_mfma_f32_16x16x32_bf16 v[88:91], v[156:159], v[216:219], v[88:91]
    v_mfma_f32_16x16x32_bf16 v[88:91], v[184:187], v[188:191], v[88:91]
    s_waitcnt lgkmcnt(0)
    v_mfma_f32_16x16x32_bf16 v[60:63], v[92:95], v[124:127], v[60:63]
    ds_read_b128 v[188:191], v224 offset:448
    v_mfma_f32_16x16x32_bf16 v[64:67], v[92:95], v[128:131], v[64:67]
    ds_read2_b32 v[156:157], v220 offset0:0 offset1:1
    v_mfma_f32_16x16x32_bf16 v[64:67], v[96:99], v[124:127], v[64:67]
    ds_read2_b32 v[158:159], v220 offset0:2 offset1:3
    v_mfma_f32_16x16x32_bf16 v[68:71], v[96:99], v[128:131], v[68:71]
    ds_read_b128 v[192:195], v224 offset:960
    v_mfma_f32_16x16x32_bf16 v[68:71], v[92:95], v[132:135], v[68:71]
    v_mfma_f32_16x16x32_bf16 v[72:75], v[96:99], v[132:135], v[72:75]
    ds_read2_b32 v[160:161], v220 offset0:128 offset1:129
    v_mfma_f32_16x16x32_bf16 v[68:71], v[100:103], v[124:127], v[68:71]
    ds_read2_b32 v[162:163], v220 offset0:130 offset1:131
    v_mfma_f32_16x16x32_bf16 v[72:75], v[100:103], v[128:131], v[72:75]
    ds_read_b128 v[196:199], v224 offset:1472
    v_mfma_f32_16x16x32_bf16 v[76:79], v[100:103], v[132:135], v[76:79]
    ds_read2_b32 v[164:165], v221 offset0:0 offset1:1
    v_mfma_f32_16x16x32_bf16 v[72:75], v[92:95], v[136:139], v[72:75]
    v_mfma_f32_16x16x32_bf16 v[76:79], v[96:99], v[136:139], v[76:79]
    ds_read2_b32 v[166:167], v221 offset0:2 offset1:3
    v_mfma_f32_16x16x32_bf16 v[80:83], v[100:103], v[136:139], v[80:83]
    ds_read_b128 v[200:203], v224 offset:1984
    v_mfma_f32_16x16x32_bf16 v[72:75], v[104:107], v[124:127], v[72:75]
    ds_read2_b32 v[168:169], v221 offset0:128 offset1:129
    v_mfma_f32_16x16x32_bf16 v[76:79], v[104:107], v[128:131], v[76:79]
    ds_read2_b32 v[170:171], v221 offset0:130 offset1:131
    v_mfma_f32_16x16x32_bf16 v[80:83], v[104:107], v[132:135], v[80:83]
    v_mfma_f32_16x16x32_bf16 v[84:87], v[104:107], v[136:139], v[84:87]
    ds_read_b128 v[204:207], v224 offset:2496
    v_mfma_f32_16x16x32_bf16 v[76:79], v[92:95], v[140:143], v[76:79]
    ds_read2_b32 v[172:173], v222 offset0:0 offset1:1
    v_mfma_f32_16x16x32_bf16 v[80:83], v[96:99], v[140:143], v[80:83]
    ds_read2_b32 v[174:175], v222 offset0:2 offset1:3
    v_mfma_f32_16x16x32_bf16 v[84:87], v[100:103], v[140:143], v[84:87]
    ds_read_b128 v[208:211], v224 offset:3008
    v_mfma_f32_16x16x32_bf16 v[88:91], v[104:107], v[140:143], v[88:91]
    v_mfma_f32_16x16x32_bf16 v[76:79], v[108:111], v[124:127], v[76:79]
    ds_read2_b32 v[176:177], v222 offset0:128 offset1:129
    v_mfma_f32_16x16x32_bf16 v[80:83], v[108:111], v[128:131], v[80:83]
    ds_read2_b32 v[178:179], v222 offset0:130 offset1:131
    v_mfma_f32_16x16x32_bf16 v[84:87], v[108:111], v[132:135], v[84:87]
    ds_read_b128 v[212:215], v224 offset:3520
    v_mfma_f32_16x16x32_bf16 v[88:91], v[108:111], v[136:139], v[88:91]
    ds_read2_b32 v[180:181], v223 offset0:0 offset1:1
    v_mfma_f32_16x16x32_bf16 v[80:83], v[92:95], v[144:147], v[80:83]
    v_mfma_f32_16x16x32_bf16 v[84:87], v[96:99], v[144:147], v[84:87]
    ds_read2_b32 v[182:183], v223 offset0:2 offset1:3
    v_mfma_f32_16x16x32_bf16 v[88:91], v[100:103], v[144:147], v[88:91]
    ds_read_b128 v[216:219], v224 offset:4032
    v_mfma_f32_16x16x32_bf16 v[80:83], v[112:115], v[124:127], v[80:83]
    ds_read2_b32 v[184:185], v223 offset0:128 offset1:129
    v_mfma_f32_16x16x32_bf16 v[84:87], v[112:115], v[128:131], v[84:87]
    ds_read2_b32 v[186:187], v223 offset0:130 offset1:131
    v_mfma_f32_16x16x32_bf16 v[88:91], v[112:115], v[132:135], v[88:91]
    v_mfma_f32_16x16x32_bf16 v[84:87], v[92:95], v[148:151], v[84:87]
    v_mfma_f32_16x16x32_bf16 v[88:91], v[96:99], v[148:151], v[88:91]
    v_mfma_f32_16x16x32_bf16 v[84:87], v[116:119], v[124:127], v[84:87]
    v_mfma_f32_16x16x32_bf16 v[88:91], v[116:119], v[128:131], v[88:91]
    v_mfma_f32_16x16x32_bf16 v[88:91], v[92:95], v[152:155], v[88:91]
    v_mfma_f32_16x16x32_bf16 v[88:91], v[120:123], v[124:127], v[88:91]
    s_waitcnt lgkmcnt(0)
    v_mfma_f32_16x16x32_bf16 v[60:63], v[156:159], v[188:191], v[60:63]
    v_mfma_f32_16x16x32_bf16 v[64:67], v[156:159], v[192:195], v[64:67]
    v_mfma_f32_16x16x32_bf16 v[64:67], v[160:163], v[188:191], v[64:67]
    v_mfma_f32_16x16x32_bf16 v[68:71], v[160:163], v[192:195], v[68:71]
    v_mfma_f32_16x16x32_bf16 v[68:71], v[156:159], v[196:199], v[68:71]
    v_mfma_f32_16x16x32_bf16 v[72:75], v[160:163], v[196:199], v[72:75]
    v_mfma_f32_16x16x32_bf16 v[68:71], v[164:167], v[188:191], v[68:71]
    v_mfma_f32_16x16x32_bf16 v[72:75], v[164:167], v[192:195], v[72:75]
    v_mfma_f32_16x16x32_bf16 v[76:79], v[164:167], v[196:199], v[76:79]
    v_mfma_f32_16x16x32_bf16 v[72:75], v[156:159], v[200:203], v[72:75]
    v_mfma_f32_16x16x32_bf16 v[76:79], v[160:163], v[200:203], v[76:79]
    v_mfma_f32_16x16x32_bf16 v[80:83], v[164:167], v[200:203], v[80:83]
    v_mfma_f32_16x16x32_bf16 v[72:75], v[168:171], v[188:191], v[72:75]
    v_mfma_f32_16x16x32_bf16 v[76:79], v[168:171], v[192:195], v[76:79]
    v_mfma_f32_16x16x32_bf16 v[80:83], v[168:171], v[196:199], v[80:83]
    v_mfma_f32_16x16x32_bf16 v[84:87], v[168:171], v[200:203], v[84:87]
    v_mfma_f32_16x16x32_bf16 v[76:79], v[156:159], v[204:207], v[76:79]
    v_mfma_f32_16x16x32_bf16 v[80:83], v[160:163], v[204:207], v[80:83]
    v_mfma_f32_16x16x32_bf16 v[84:87], v[164:167], v[204:207], v[84:87]
    v_mfma_f32_16x16x32_bf16 v[88:91], v[168:171], v[204:207], v[88:91]
    v_mfma_f32_16x16x32_bf16 v[76:79], v[172:175], v[188:191], v[76:79]
    v_mfma_f32_16x16x32_bf16 v[80:83], v[172:175], v[192:195], v[80:83]
    v_mfma_f32_16x16x32_bf16 v[84:87], v[172:175], v[196:199], v[84:87]
    v_mfma_f32_16x16x32_bf16 v[88:91], v[172:175], v[200:203], v[88:91]
    v_mfma_f32_16x16x32_bf16 v[80:83], v[156:159], v[208:211], v[80:83]
    v_mfma_f32_16x16x32_bf16 v[84:87], v[160:163], v[208:211], v[84:87]
    v_mfma_f32_16x16x32_bf16 v[88:91], v[164:167], v[208:211], v[88:91]
    v_mfma_f32_16x16x32_bf16 v[80:83], v[176:179], v[188:191], v[80:83]
    v_mfma_f32_16x16x32_bf16 v[84:87], v[176:179], v[192:195], v[84:87]
    v_mfma_f32_16x16x32_bf16 v[88:91], v[176:179], v[196:199], v[88:91]
    v_mfma_f32_16x16x32_bf16 v[84:87], v[156:159], v[212:215], v[84:87]
    v_mfma_f32_16x16x32_bf16 v[88:91], v[160:163], v[212:215], v[88:91]
    v_mfma_f32_16x16x32_bf16 v[84:87], v[180:183], v[188:191], v[84:87]
    v_mfma_f32_16x16x32_bf16 v[88:91], v[180:183], v[192:195], v[88:91]
    v_mfma_f32_16x16x32_bf16 v[88:91], v[156:159], v[216:219], v[88:91]
    v_mfma_f32_16x16x32_bf16 v[88:91], v[184:187], v[188:191], v[88:91]
    s_lshl_b32 s61, s71, 12
    s_add_u32 s61, s61, 13631488
    v_cvt_pk_bf16_f32 v128, v60, v61
    v_cvt_pk_bf16_f32 v129, v62, v63
    buffer_store_dwordx2 v[128:129], v225, s[44:47], s61 offen offset:0 sc1
    v_cvt_pk_bf16_f32 v130, v64, v65
    v_cvt_pk_bf16_f32 v131, v66, v67
    buffer_store_dwordx2 v[130:131], v225, s[44:47], s61 offen offset:512 sc1
    v_cvt_pk_bf16_f32 v132, v68, v69
    v_cvt_pk_bf16_f32 v133, v70, v71
    buffer_store_dwordx2 v[132:133], v225, s[44:47], s61 offen offset:1024 sc1
    v_cvt_pk_bf16_f32 v134, v72, v73
    v_cvt_pk_bf16_f32 v135, v74, v75
    buffer_store_dwordx2 v[134:135], v225, s[44:47], s61 offen offset:1536 sc1
    v_cvt_pk_bf16_f32 v136, v76, v77
    v_cvt_pk_bf16_f32 v137, v78, v79
    buffer_store_dwordx2 v[136:137], v225, s[44:47], s61 offen offset:2048 sc1
    v_cvt_pk_bf16_f32 v138, v80, v81
    v_cvt_pk_bf16_f32 v139, v82, v83
    buffer_store_dwordx2 v[138:139], v225, s[44:47], s61 offen offset:2560 sc1
    v_cvt_pk_bf16_f32 v140, v84, v85
    v_cvt_pk_bf16_f32 v141, v86, v87
    buffer_store_dwordx2 v[140:141], v225, s[44:47], s61 offen offset:3072 sc1
    v_cvt_pk_bf16_f32 v142, v88, v89
    v_cvt_pk_bf16_f32 v143, v90, v91
    buffer_store_dwordx2 v[142:143], v225, s[44:47], s61 offen offset:3584 sc1
    s_lshl_b32 s60, s70, 2
    s_add_u32 s60, s60, 161664
    v_mov_b32 v2, s60
    v_mov_b32 v3, 1
    ds_write_b32 v2, v3
    s_mul_i32 s66, s71, 128
    s_add_u32 s66, s66, 16400384
    s_waitcnt vmcnt(0)
    v_mov_b32 v2, s96
    s_mov_b64 s[62:63], exec
    s_mov_b64 exec, 1
    buffer_store_dword v2, off, s[44:47], s66 sc1
    s_mov_b64 exec, s[62:63]
    s_endpgm
fused_noch:
    s_sub_u32 s70, s34, 4
    s_cmp_eq_u32 s34, 6
    s_cbranch_scc1 fused_rt
    s_waitcnt vmcnt(0)
    s_cmp_lg_u32 s34, 4
    s_cbranch_scc1 fused_end
    v_mov_b32 v2, 161576
    s_mov_b32 s61, 0
fused_agw:
    ds_read_b32 v3, v2
    s_add_u32 s61, s61, 1
    s_waitcnt lgkmcnt(0)
    v_readfirstlane_b32 s60, v3
    s_cmp_gt_u32 s61, 0x200000
    s_cbranch_scc1 fused_agw_d
    s_cmp_ge_u32 s60, 4
    s_cbranch_scc1 fused_agw_d
    s_sleep 2
    s_branch fused_agw
fused_agw_d:
    v_mov_b32 v2, 161680
    s_mov_b32 s61, 0
fused_an:
    ds_read_b128 v[4:7], v2
    s_add_u32 s61, s61, 1
    s_waitcnt lgkmcnt(0)
    v_readfirstlane_b32 s60, v4
    s_cmp_gt_u32 s61, 0x200000
    s_cbranch_scc1 fused_an_d
    s_cmp_lg_u32 s60, 0
    s_cbranch_scc1 fused_an_d
    s_sleep 1
    s_branch fused_an
fused_an_d:
    s_mov_b32 s96, s60
    s_lshl_b32 s67, s35, 1
    s_add_u32 s67, s67, s36
    s_sub_u32 s67, s67, 30
    s_mul_i32 s66, s67, 2048
    s_add_u32 s66, s66, 16547840
    s_add_u32 s62, s32, s66
    s_addc_u32 s63, s33, 0
    s_mov_b32 s64, 0
fused_plt:
    s_load_dword s4, s[62:63], 0 glc
    s_load_dword s5, s[62:63], 128 glc
    s_load_dword s6, s[62:63], 256 glc
    s_load_dword s7, s[62:63], 384 glc
    s_load_dword s8, s[62:63], 512 glc
    s_load_dword s9, s[62:63], 640 glc
    s_load_dword s10, s[62:63], 768 glc
    s_load_dword s11, s[62:63], 896 glc
    s_load_dword s12, s[62:63], 1024 glc
    s_load_dword s13, s[62:63], 1152 glc
    s_load_dword s14, s[62:63], 1280 glc
    s_load_dword s15, s[62:63], 1408 glc
    s_load_dword s16, s[62:63], 1536 glc
    s_load_dword s17, s[62:63], 1664 glc
    s_load_dword s18, s[62:63], 1792 glc
    s_load_dword s19, s[62:63], 1920 glc
    s_add_u32 s64, s64, 1
    s_waitcnt lgkmcnt(0)
    s_xor_b32 s4, s4, s96
    s_xor_b32 s5, s5, s96
    s_xor_b32 s6, s6, s96
    s_xor_b32 s7, s7, s96
    s_xor_b32 s8, s8, s96
    s_xor_b32 s9, s9, s96
    s_xor_b32 s10, s10, s96
    s_xor_b32 s11, s11, s96
    s_xor_b32 s12, s12, s96
    s_xor_b32 s13, s13, s96
    s_xor_b32 s14, s14, s96
    s_xor_b32 s15, s15, s96
    s_xor_b32 s16, s16, s96
    s_xor_b32 s17, s17, s96
    s_xor_b32 s18, s18, s96
    s_xor_b32 s19, s19, s96
    s_or_b32 s4, s4, s5
    s_or_b32 s6, s6, s7
    s_or_b32 s4, s4, s6
    s_or_b32 s8, s8, s9
    s_or_b32 s10, s10, s11
    s_or_b32 s8, s8, s10
    s_or_b32 s12, s12, s13
    s_or_b32 s14, s14, s15
    s_or_b32 s12, s12, s14
    s_or_b32 s16, s16, s17
    s_or_b32 s18, s18, s19
    s_or_b32 s16, s16, s18
    s_or_b32 s4, s4, s8
    s_or_b32 s4, s4, s12
    s_or_b32 s4, s4, s16
    s_cmp_eq_u32 s4, 0
    s_cbranch_scc1 fused_plt_d
    s_sleep 2
    s_cmp_lt_u32 s64, 0x20000
    s_cbranch_scc1 fused_plt
fused_plt_d:
    s_mul_i32 s66, s67, 128
    s_add_u32 s66, s66, 16580608
    v_mul_u32_u24 v2, 2048, v0
    v_mov_b32 v3, s96
    s_mov_b64 exec, 0xffff
    buffer_store_dword v3, v2, s[44:47], s66 offen sc1
    s_mov_b64 exec, -1
    s_endpgm
fused_rt:
    s_mov_b32 s56, s24
    s_and_b32 s57, s25, 0xffff
    s_mov_b32 s58, 1966080
    s_mov_b32 s59, 0x00020000
    s_lshr_b32 s91, s43, 1
    s_and_b32 s92, s43, 1
    s_mul_i32 s62, s91, 40960
    s_mul_i32 s63, s92, 640
    s_add_u32 s62, s62, s63
    s_add_u32 s63, s62, 320
    v_add_u32 v1, 0, v0
    v_mul_u32_u24 v2, 52429, v1
    v_lshrrev_b32 v2, 20, v2
    v_mul_u32_u24 v3, 20, v2
    v_sub_u32 v3, v1, v3
    v_mul_u32_u24 v2, 1280, v2
    v_lshl_add_u32 v2, v3, 4, v2
    buffer_load_dwordx4 v[64:67], v2, s[56:59], s62 offen
    buffer_load_dwordx4 v[104:107], v2, s[56:59], s63 offen
    v_add_u32 v1, 64, v0
    v_mul_u32_u24 v2, 52429, v1
    v_lshrrev_b32 v2, 20, v2
    v_mul_u32_u24 v3, 20, v2
    v_sub_u32 v3, v1, v3
    v_mul_u32_u24 v2, 1280, v2
    v_lshl_add_u32 v2, v3, 4, v2
    buffer_load_dwordx4 v[68:71], v2, s[56:59], s62 offen
    buffer_load_dwordx4 v[108:111], v2, s[56:59], s63 offen
    v_add_u32 v1, 128, v0
    v_mul_u32_u24 v2, 52429, v1
    v_lshrrev_b32 v2, 20, v2
    v_mul_u32_u24 v3, 20, v2
    v_sub_u32 v3, v1, v3
    v_mul_u32_u24 v2, 1280, v2
    v_lshl_add_u32 v2, v3, 4, v2
    buffer_load_dwordx4 v[72:75], v2, s[56:59], s62 offen
    buffer_load_dwordx4 v[112:115], v2, s[56:59], s63 offen
    v_add_u32 v1, 192, v0
    v_mul_u32_u24 v2, 52429, v1
    v_lshrrev_b32 v2, 20, v2
    v_mul_u32_u24 v3, 20, v2
    v_sub_u32 v3, v1, v3
    v_mul_u32_u24 v2, 1280, v2
    v_lshl_add_u32 v2, v3, 4, v2
    buffer_load_dwordx4 v[76:79], v2, s[56:59], s62 offen
    buffer_load_dwordx4 v[116:119], v2, s[56:59], s63 offen
    v_add_u32 v1, 256, v0
    v_mul_u32_u24 v2, 52429, v1
    v_lshrrev_b32 v2, 20, v2
    v_mul_u32_u24 v3, 20, v2
    v_sub_u32 v3, v1, v3
    v_mul_u32_u24 v2, 1280, v2
    v_lshl_add_u32 v2, v3, 4, v2
    buffer_load_dwordx4 v[80:83], v2, s[56:59], s62 offen
    buffer_load_dwordx4 v[120:123], v2, s[56:59], s63 offen
    v_add_u32 v1, 320, v0
    v_mul_u32_u24 v2, 52429, v1
    v_lshrrev_b32 v2, 20, v2
    v_mul_u32_u24 v3, 20, v2
    v_sub_u32 v3, v1, v3
    v_mul_u32_u24 v2, 1280, v2
    v_lshl_add_u32 v2, v3, 4, v2
    buffer_load_dwordx4 v[84:87], v2, s[56:59], s62 offen
    buffer_load_dwordx4 v[124:127], v2, s[56:59], s63 offen
    v_add_u32 v1, 384, v0
    v_mul_u32_u24 v2, 52429, v1
    v_lshrrev_b32 v2, 20, v2
    v_mul_u32_u24 v3, 20, v2
    v_sub_u32 v3, v1, v3
    v_mul_u32_u24 v2, 1280, v2
    v_lshl_add_u32 v2, v3, 4, v2
    buffer_load_dwordx4 v[88:91], v2, s[56:59], s62 offen
    buffer_load_dwordx4 v[128:131], v2, s[56:59], s63 offen
    v_add_u32 v1, 448, v0
    v_mul_u32_u24 v2, 52429, v1
    v_lshrrev_b32 v2, 20, v2
    v_mul_u32_u24 v3, 20, v2
    v_sub_u32 v3, v1, v3
    v_mul_u32_u24 v2, 1280, v2
    v_lshl_add_u32 v2, v3, 4, v2
    buffer_load_dwordx4 v[92:95], v2, s[56:59], s62 offen
    buffer_load_dwordx4 v[132:135], v2, s[56:59], s63 offen
    v_add_u32 v1, 512, v0
    v_mul_u32_u24 v2, 52429, v1
    v_lshrrev_b32 v2, 20, v2
    v_mul_u32_u24 v3, 20, v2
    v_sub_u32 v3, v1, v3
    v_mul_u32_u24 v2, 1280, v2
    v_lshl_add_u32 v2, v3, 4, v2
    buffer_load_dwordx4 v[96:99], v2, s[56:59], s62 offen
    buffer_load_dwordx4 v[136:139], v2, s[56:59], s63 offen
    v_add_u32 v1, 576, v0
    v_mul_u32_u24 v2, 52429, v1
    v_lshrrev_b32 v2, 20, v2
    v_mul_u32_u24 v3, 20, v2
    v_sub_u32 v3, v1, v3
    v_mul_u32_u24 v2, 1280, v2
    v_lshl_add_u32 v2, v3, 4, v2
    buffer_load_dwordx4 v[100:103], v2, s[56:59], s62 offen
    buffer_load_dwordx4 v[140:143], v2, s[56:59], s63 offen
    s_mov_b32 s52, s20
    s_and_b32 s53, s21, 0xffff
    s_mov_b32 s54, 1966080
    s_mov_b32 s55, 0x00020000
    v_add_u32 v5, 0, v0
    v_mul_u32_u24 v6, 43691, v5
    v_lshrrev_b32 v6, 19, v6
    v_mul_u32_u24 v7, 12, v6
    v_sub_u32 v7, v5, v7
    v_lshrrev_b32 v8, 2, v6
    v_and_b32 v8, 2, v8
    v_xor_b32 v7, v7, v8
    v_mul_u32_u24 v6, 3072, v6
    v_lshl_add_u32 v12, v7, 4, v6
    v_add_u32 v5, 64, v0
    v_mul_u32_u24 v6, 43691, v5
    v_lshrrev_b32 v6, 19, v6
    v_mul_u32_u24 v7, 12, v6
    v_sub_u32 v7, v5, v7
    v_lshrrev_b32 v8, 2, v6
    v_and_b32 v8, 2, v8
    v_xor_b32 v7, v7, v8
    v_mul_u32_u24 v6, 3072, v6
    v_lshl_add_u32 v13, v7, 4, v6
    v_add_u32 v5, 128, v0
    v_mul_u32_u24 v6, 43691, v5
    v_lshrrev_b32 v6, 19, v6
    v_mul_u32_u24 v7, 12, v6
    v_sub_u32 v7, v5, v7
    v_lshrrev_b32 v8, 2, v6
    v_and_b32 v8, 2, v8
    v_xor_b32 v7, v7, v8
    v_mul_u32_u24 v6, 3072, v6
    v_lshl_add_u32 v14, v7, 4, v6
    s_mul_i32 s69, s38, 192
    s_mov_b32 s68, 24
fused_h6l:
    s_mul_i32 s63, s68, 49152
    s_add_u32 s63, s63, s69
    s_mul_i32 m0, s68, 3072
    s_nop 0
    buffer_load_dwordx4 v12, s[52:55], s63 offen lds
    s_add_u32 m0, m0, 1024
    s_nop 0
    buffer_load_dwordx4 v13, s[52:55], s63 offen lds
    s_add_u32 m0, m0, 1024
    s_nop 0
    buffer_load_dwordx4 v14, s[52:55], s63 offen lds
    s_add_u32 s68, s68, 1
    s_cmp_lt_u32 s68, 36
    s_cbranch_scc1 fused_h6l
    s_waitcnt vmcnt(36)
    v_mov_b32 v2, 161576
    s_mov_b32 s61, 0
fused_rtw:
    ds_read_b32 v3, v2
    s_add_u32 s61, s61, 1
    s_waitcnt lgkmcnt(0)
    v_readfirstlane_b32 s60, v3
    s_cmp_gt_u32 s61, 0x200000
    s_cbranch_scc1 fused_rtw_d
    s_cmp_ge_u32 s60, 4
    s_cbranch_scc1 fused_rtw_d
    s_sleep 2
    s_branch fused_rtw
fused_rtw_d:
    s_setprio 3
    v_lshlrev_b32 v6, 4, v0
    v_add_u32 v1, 148672, v6
    v_lshrrev_b32 v2, 4, v0
    v_and_b32 v3, 15, v0
    v_lshrrev_b32 v3, 2, v3
    v_lshl_add_u32 v2, v2, 2, v3
    v_mul_u32_u24 v2, 320, v2
    v_and_b32 v3, 3, v0
    v_lshl_add_u32 v2, v3, 3, v2
    v_add_u32 v2, 148672, v2
    s_mul_i32 s62, s92, 983040
    s_mul_i32 s63, s91, 5120
    s_add_u32 s62, s62, s63
    s_add_u32 s62, s62, 11534336
    v_add_u32 v7, 4096, v6
    ds_write_b128 v1, v[64:67] offset:0
    ds_write_b128 v1, v[68:71] offset:1024
    ds_write_b128 v1, v[72:75] offset:2048
    ds_write_b128 v1, v[76:79] offset:3072
    ds_write_b128 v1, v[80:83] offset:4096
    ds_write_b128 v1, v[84:87] offset:5120
    ds_write_b128 v1, v[88:91] offset:6144
    ds_write_b128 v1, v[92:95] offset:7168
    ds_write_b128 v1, v[96:99] offset:8192
    ds_write_b128 v1, v[100:103] offset:9216
    s_waitcnt lgkmcnt(4)
    ds_read_b64_tr_b16 v[144:145], v2 offset:0
    ds_read_b64_tr_b16 v[146:147], v2 offset:5120
    ds_read_b64_tr_b16 v[148:149], v2 offset:32
    ds_read_b64_tr_b16 v[150:151], v2 offset:5152
    ds_read_b64_tr_b16 v[152:153], v2 offset:64
    ds_read_b64_tr_b16 v[154:155], v2 offset:5184
    ds_read_b64_tr_b16 v[156:157], v2 offset:96
    ds_read_b64_tr_b16 v[158:159], v2 offset:5216
    ds_read_b64_tr_b16 v[160:161], v2 offset:128
    ds_read_b64_tr_b16 v[162:163], v2 offset:5248
    s_waitcnt lgkmcnt(4)
    ds_read_b64_tr_b16 v[164:165], v2 offset:160
    ds_read_b64_tr_b16 v[166:167], v2 offset:5280
    ds_read_b64_tr_b16 v[168:169], v2 offset:192
    ds_read_b64_tr_b16 v[170:171], v2 offset:5312
    ds_read_b64_tr_b16 v[172:173], v2 offset:224
    ds_read_b64_tr_b16 v[174:175], v2 offset:5344
    ds_read_b64_tr_b16 v[176:177], v2 offset:256
    ds_read_b64_tr_b16 v[178:179], v2 offset:5376
    ds_read_b64_tr_b16 v[180:181], v2 offset:288
    ds_read_b64_tr_b16 v[182:183], v2 offset:5408
    s_waitcnt lgkmcnt(0)
    s_add_u32 s63, s62, 0
    buffer_store_dwordx4 v[144:147], v6, s[44:47], s63 offen offset:0 sc1
    buffer_store_dwordx4 v[148:151], v6, s[44:47], s63 offen offset:1024 sc1
    buffer_store_dwordx4 v[152:155], v6, s[44:47], s63 offen offset:2048 sc1
    buffer_store_dwordx4 v[156:159], v6, s[44:47], s63 offen offset:3072 sc1
    buffer_store_dwordx4 v[160:163], v7, s[44:47], s63 offen sc1
    s_add_u32 s63, s62, 245760
    buffer_store_dwordx4 v[164:167], v6, s[44:47], s63 offen offset:0 sc1
    buffer_store_dwordx4 v[168:171], v6, s[44:47], s63 offen offset:1024 sc1
    buffer_store_dwordx4 v[172:175], v6, s[44:47], s63 offen offset:2048 sc1
    buffer_store_dwordx4 v[176:179], v6, s[44:47], s63 offen offset:3072 sc1
    buffer_store_dwordx4 v[180:183], v7, s[44:47], s63 offen sc1
    v_mov_b32 v8, v2
    s_waitcnt vmcnt(10)
    v_mov_b32 v2, 161580
    v_mov_b32 v3, 1
    s_mov_b64 exec, 1
    ds_add_u32 v2, v3
    s_mov_b64 exec, -1
    v_mov_b32 v2, v8
    ds_write_b128 v1, v[104:107] offset:0
    ds_write_b128 v1, v[108:111] offset:1024
    ds_write_b128 v1, v[112:115] offset:2048
    ds_write_b128 v1, v[116:119] offset:3072
    ds_write_b128 v1, v[120:123] offset:4096
    ds_write_b128 v1, v[124:127] offset:5120
    ds_write_b128 v1, v[128:131] offset:6144
    ds_write_b128 v1, v[132:135] offset:7168
    ds_write_b128 v1, v[136:139] offset:8192
    ds_write_b128 v1, v[140:143] offset:9216
    s_waitcnt lgkmcnt(4)
    ds_read_b64_tr_b16 v[184:185], v2 offset:0
    ds_read_b64_tr_b16 v[186:187], v2 offset:5120
    ds_read_b64_tr_b16 v[188:189], v2 offset:32
    ds_read_b64_tr_b16 v[190:191], v2 offset:5152
    ds_read_b64_tr_b16 v[192:193], v2 offset:64
    ds_read_b64_tr_b16 v[194:195], v2 offset:5184
    ds_read_b64_tr_b16 v[196:197], v2 offset:96
    ds_read_b64_tr_b16 v[198:199], v2 offset:5216
    ds_read_b64_tr_b16 v[200:201], v2 offset:128
    ds_read_b64_tr_b16 v[202:203], v2 offset:5248
    s_waitcnt lgkmcnt(4)
    ds_read_b64_tr_b16 v[204:205], v2 offset:160
    ds_read_b64_tr_b16 v[206:207], v2 offset:5280
    ds_read_b64_tr_b16 v[208:209], v2 offset:192
    ds_read_b64_tr_b16 v[210:211], v2 offset:5312
    ds_read_b64_tr_b16 v[212:213], v2 offset:224
    ds_read_b64_tr_b16 v[214:215], v2 offset:5344
    ds_read_b64_tr_b16 v[216:217], v2 offset:256
    ds_read_b64_tr_b16 v[218:219], v2 offset:5376
    ds_read_b64_tr_b16 v[220:221], v2 offset:288
    ds_read_b64_tr_b16 v[222:223], v2 offset:5408
    s_waitcnt lgkmcnt(0)
    s_add_u32 s63, s62, 491520
    buffer_store_dwordx4 v[184:187], v6, s[44:47], s63 offen offset:0 sc1
    buffer_store_dwordx4 v[188:191], v6, s[44:47], s63 offen offset:1024 sc1
    buffer_store_dwordx4 v[192:195], v6, s[44:47], s63 offen offset:2048 sc1
    buffer_store_dwordx4 v[196:199], v6, s[44:47], s63 offen offset:3072 sc1
    buffer_store_dwordx4 v[200:203], v7, s[44:47], s63 offen sc1
    s_add_u32 s63, s62, 737280
    buffer_store_dwordx4 v[204:207], v6, s[44:47], s63 offen offset:0 sc1
    buffer_store_dwordx4 v[208:211], v6, s[44:47], s63 offen offset:1024 sc1
    buffer_store_dwordx4 v[212:215], v6, s[44:47], s63 offen offset:2048 sc1
    buffer_store_dwordx4 v[216:219], v6, s[44:47], s63 offen offset:3072 sc1
    buffer_store_dwordx4 v[220:223], v7, s[44:47], s63 offen sc1
    v_mov_b32 v3, 0
    s_mov_b32 s64, 0
fused_wn:
    global_load_dword v2, v3, s[30:31] sc1
    s_add_u32 s64, s64, 1
    s_waitcnt vmcnt(0)
    s_nop 1
    v_readfirstlane_b32 s96, v2
    s_cmp_gt_u32 s64, 0x20000
    s_cbranch_scc1 fused_wnd
    s_cmp_eq_u32 s96, 0
    s_cbranch_scc1 fused_wn
fused_wnd:
    s_mul_i32 s66, s43, 128
    s_add_u32 s66, s66, 16646144
    v_mul_u32_u24 v2, 12288, v0
    v_mov_b32 v3, s96
    s_mov_b64 exec, 0xff
    s_waitcnt vmcnt(0)
    buffer_store_dword v3, v2, s[44:47], s66 offen sc1
    s_mov_b64 exec, -1
    s_endpgm
fused_svc:
    s_waitcnt vmcnt(0)
    v_mov_b32 v2, 161580
    v_mov_b32 v3, 1
    s_mov_b64 exec, 1
    ds_add_u32 v2, v3
    s_mov_b64 exec, -1
    s_setprio 3
    v_mov_b32 v2, 161680
    s_mov_b32 s61, 0
fused_sn:
    ds_read_b128 v[4:7], v2
    s_add_u32 s61, s61, 1
    s_waitcnt lgkmcnt(0)
    v_readfirstlane_b32 s60, v4
    s_cmp_gt_u32 s61, 0x200000
    s_cbranch_scc1 fused_sn_d
    s_cmp_lg_u32 s60, 0
    s_cbranch_scc1 fused_sn_d
    s_sleep 1
    s_branch fused_sn
fused_sn_d:
    s_mov_b32 s96, s60
    s_mul_i32 s66, s35, 12288
    s_lshr_b32 s60, s40, 2
    s_mul_i32 s60, s60, 128
    s_add_u32 s66, s66, s60
    s_add_u32 s66, s66, 16646144
    s_mov_b32 s67, s66
    v_mov_b32 v2, 161792
    s_mov_b32 s61, 0
fused_slw:
    ds_read_b128 v[4:7], v2
    s_add_u32 s61, s61, 1
    s_waitcnt lgkmcnt(0)
    v_readfirstlane_b32 s60, v4
    s_cmp_gt_u32 s61, 0x200000
    s_cbranch_scc1 fused_slw_d
    s_cmp_lg_u32 s60, 0
    s_cbranch_scc1 fused_slw_d
    s_sleep 2
    s_branch fused_slw
fused_slw_d:
    s_mov_b32 s65, 0
    s_cmp_eq_u32 s41, 0
    s_cbranch_scc1 fused_nou
    s_and_b32 s66, s2, 15
    s_mul_i32 s66, s66, 2048
    s_add_u32 s66, s66, 16580608
    v_mul_u32_u24 v2, 128, v0
    s_sub_u32 s60, s67, 4096
    v_lshlrev_b32 v4, 1, v2
    v_add_u32 v4, s60, v4
    s_and_b32 s60, s2, 15
    s_mul_i32 s60, s60, 2048
    s_add_u32 s60, s60, 16580608
    v_add_u32 v2, s60, v2
    v_cmp_gt_u32 vcc, 16, v0
    s_nop 1
    v_cndmask_b32 v2, v4, v2, vcc
    v_mov_b32 v4, 161632
    s_mov_b32 s64, 0
fused_pla:
    buffer_load_dword v3, v2, s[44:47], 0 offen sc1
    s_add_u32 s64, s64, 1
    s_waitcnt vmcnt(0)
    v_cmp_ne_u32 vcc, s96, v3
    s_cmp_gt_u32 s64, 0x20000
    s_nop 0
    s_cselect_b64 s[60:61], 0, vcc
    s_lshr_b64 s[62:63], s[60:61], 16
    s_cmp_eq_u64 s[62:63], 0
    s_cselect_b32 s65, 1, 0
    v_mov_b32 v3, s65
    ds_write_b32 v4, v3
    s_and_b32 s60, s60, 0xffff
    s_cmp_eq_u32 s60, 0
    s_cbranch_scc1 fused_pla_d
    s_sleep 3
    s_branch fused_pla
fused_pla_d:
    s_mov_b64 exec, -1
    v_lshrrev_b32 v2, 2, v0
    v_and_b32 v3, 3, v0
    v_mul_u32_u24 v4, 10240, v2
    v_lshl_add_u32 v4, v3, 4, v4
    s_lshl_b32 s60, s42, 4
    s_add_u32 s60, s60, 2621440
    v_mul_u32_u24 v5, 12896, v3
    v_lshl_add_u32 v5, v2, 4, v5
    v_add_u32 v5, 131680, v5
    v_cmp_gt_u32 vcc, s41, v3
    s_mov_b64 s[62:63], exec
    s_nop 0
    s_and_b64 exec, exec, vcc
    buffer_load_dwordx4 v[40:43], v4, s[44:47], s60 offen sc1
    s_add_u32 s60, s60, 163840
    buffer_load_dwordx4 v[44:47], v4, s[44:47], s60 offen sc1
    s_add_u32 s60, s60, 163840
    buffer_load_dwordx4 v[48:51], v4, s[44:47], s60 offen sc1
    s_add_u32 s60, s60, 163840
    buffer_load_dwordx4 v[52:55], v4, s[44:47], s60 offen sc1
    s_add_u32 s60, s60, 163840
    buffer_load_dwordx4 v[56:59], v4, s[44:47], s60 offen sc1
    s_add_u32 s60, s60, 163840
    buffer_load_dwordx4 v[60:63], v4, s[44:47], s60 offen sc1
    s_add_u32 s60, s60, 163840
    buffer_load_dwordx4 v[64:67], v4, s[44:47], s60 offen sc1
    s_add_u32 s60, s60, 163840
    buffer_load_dwordx4 v[68:71], v4, s[44:47], s60 offen sc1
    s_add_u32 s60, s60, 163840
    buffer_load_dwordx4 v[72:75], v4, s[44:47], s60 offen sc1
    s_add_u32 s60, s60, 163840
    buffer_load_dwordx4 v[76:79], v4, s[44:47], s60 offen sc1
    s_add_u32 s60, s60, 163840
    buffer_load_dwordx4 v[80:83], v4, s[44:47], s60 offen sc1
    s_add_u32 s60, s60, 163840
    buffer_load_dwordx4 v[84:87], v4, s[44:47], s60 offen sc1
    s_add_u32 s60, s60, 163840
    buffer_load_dwordx4 v[88:91], v4, s[44:47], s60 offen sc1
    s_add_u32 s60, s60, 163840
    buffer_load_dwordx4 v[92:95], v4, s[44:47], s60 offen sc1
    s_add_u32 s60, s60, 163840
    buffer_load_dwordx4 v[96:99], v4, s[44:47], s60 offen sc1
    s_add_u32 s60, s60, 163840
    buffer_load_dwordx4 v[100:103], v4, s[44:47], s60 offen sc1
    s_waitcnt vmcnt(14)
    ds_write_b128 v5, v[40:43] offset:0
    s_waitcnt vmcnt(13)
    ds_write_b128 v5, v[44:47] offset:256
    s_waitcnt vmcnt(12)
    ds_write_b128 v5, v[48:51] offset:512
    s_waitcnt vmcnt(11)
    ds_write_b128 v5, v[52:55] offset:768
    s_waitcnt vmcnt(10)
    ds_write_b128 v5, v[56:59] offset:1024
    s_waitcnt vmcnt(9)
    ds_write_b128 v5, v[60:63] offset:1280
    s_waitcnt vmcnt(8)
    ds_write_b128 v5, v[64:67] offset:1536
    s_waitcnt vmcnt(7)
    ds_write_b128 v5, v[68:71] offset:1792
    s_waitcnt vmcnt(6)
    ds_write_b128 v5, v[72:75] offset:2048
    s_waitcnt vmcnt(5)
    ds_write_b128 v5, v[76:79] offset:2304
    s_waitcnt vmcnt(4)
    ds_write_b128 v5, v[80:83] offset:2560
    s_waitcnt vmcnt(3)
    ds_write_b128 v5, v[84:87] offset:2816
    s_waitcnt vmcnt(2)
    ds_write_b128 v5, v[88:91] offset:3072
    s_waitcnt vmcnt(1)
    ds_write_b128 v5, v[92:95] offset:3328
    s_waitcnt vmcnt(0)
    ds_write_b128 v5, v[96:99] offset:3584
    s_nop 7
    ds_write_b128 v5, v[100:103] offset:3840
    s_mov_b64 exec, s[62:63]
    s_waitcnt lgkmcnt(0)
    v_mov_b32 v2, 161616
    v_mov_b32 v3, 1
    ds_write_b32 v2, v3
fused_nou:
    s_cmp_lg_u32 s65, 0
    s_cbranch_scc1 fused_fwok
    v_mul_u32_u24 v2, 128, v0
    s_sub_u32 s60, s67, 4096
    v_lshlrev_b32 v4, 1, v2
    v_add_u32 v4, s60, v4
    s_and_b32 s60, s2, 15
    s_mul_i32 s60, s60, 2048
    s_add_u32 s60, s60, 16580608
    v_add_u32 v2, s60, v2
    v_cmp_gt_u32 vcc, 16, v0
    s_nop 1
    v_cndmask_b32 v2, v4, v2, vcc
    v_mov_b32 v4, 161632
    s_lshl_b64 exec, -1, 16
    s_mov_b32 s64, 0
fused_plb:
    buffer_load_dword v3, v2, s[44:47], 0 offen sc1
    s_add_u32 s64, s64, 1
    s_waitcnt vmcnt(0)
    v_cmp_ne_u32 vcc, s96, v3
    s_cmp_gt_u32 s64, 0x20000
    s_nop 0
    s_cselect_b64 s[60:61], 0, vcc
    s_lshr_b64 s[62:63], s[60:61], 16
    s_cmp_eq_u64 s[62:63], 0
    s_cselect_b32 s65, 1, 0
    v_mov_b32 v3, s65
    ds_write_b32 v4, v3
    s_xor_b32 s60, s65, 1
    s_cmp_eq_u32 s60, 0
    s_cbranch_scc1 fused_plb_d
    s_sleep 3
    s_branch fused_plb
fused_plb_d:
    s_mov_b64 exec, -1
fused_fwok:
    s_mul_i32 s60, s39, 81920
    s_mul_i32 s61, s40, 160
    s_add_u32 s60, s60, s61
    v_add_u32 v2, 0, v0
    v_mul_u32_u24 v3, 52429, v2
    v_lshrrev_b32 v3, 19, v3
    v_mul_u32_u24 v4, 10, v3
    v_sub_u32 v4, v2, v4
    v_lshlrev_b32 v4, 4, v4
    v_mul_u32_u24 v5, 176, v3
    v_add_u32 v184, v5, v4
    v_mul_u32_u24 v3, 1280, v3
    v_add_u32 v3, v3, v4
    buffer_load_dwordx4 v[140:143], v3, s[48:51], s60 offen
    v_add_u32 v2, 64, v0
    v_mul_u32_u24 v3, 52429, v2
    v_lshrrev_b32 v3, 19, v3
    v_mul_u32_u24 v4, 10, v3
    v_sub_u32 v4, v2, v4
    v_lshlrev_b32 v4, 4, v4
    v_mul_u32_u24 v5, 176, v3
    v_add_u32 v185, v5, v4
    v_mul_u32_u24 v3, 1280, v3
    v_add_u32 v3, v3, v4
    buffer_load_dwordx4 v[144:147], v3, s[48:51], s60 offen
    v_add_u32 v2, 128, v0
    v_mul_u32_u24 v3, 52429, v2
    v_lshrrev_b32 v3, 19, v3
    v_mul_u32_u24 v4, 10, v3
    v_sub_u32 v4, v2, v4
    v_lshlrev_b32 v4, 4, v4
    v_mul_u32_u24 v5, 176, v3
    v_add_u32 v186, v5, v4
    v_mul_u32_u24 v3, 1280, v3
    v_add_u32 v3, v3, v4
    buffer_load_dwordx4 v[148:151], v3, s[48:51], s60 offen
    v_add_u32 v2, 192, v0
    v_mul_u32_u24 v3, 52429, v2
    v_lshrrev_b32 v3, 19, v3
    v_mul_u32_u24 v4, 10, v3
    v_sub_u32 v4, v2, v4
    v_lshlrev_b32 v4, 4, v4
    v_mul_u32_u24 v5, 176, v3
    v_add_u32 v187, v5, v4
    v_mul_u32_u24 v3, 1280, v3
    v_add_u32 v3, v3, v4
    buffer_load_dwordx4 v[152:155], v3, s[48:51], s60 offen
    v_add_u32 v2, 256, v0
    v_mul_u32_u24 v3, 52429, v2
    v_lshrrev_b32 v3, 19, v3
    v_mul_u32_u24 v4, 10, v3
    v_sub_u32 v4, v2, v4
    v_lshlrev_b32 v4, 4, v4
    v_mul_u32_u24 v5, 176, v3
    v_add_u32 v188, v5, v4
    v_mul_u32_u24 v3, 1280, v3
    v_add_u32 v3, v3, v4
    buffer_load_dwordx4 v[156:159], v3, s[48:51], s60 offen
    v_add_u32 v2, 320, v0
    v_mul_u32_u24 v3, 52429, v2
    v_lshrrev_b32 v3, 19, v3
    v_mul_u32_u24 v4, 10, v3
    v_sub_u32 v4, v2, v4
    v_lshlrev_b32 v4, 4, v4
    v_mul_u32_u24 v5, 176, v3
    v_add_u32 v189, v5, v4
    v_mul_u32_u24 v3, 1280, v3
    v_add_u32 v3, v3, v4
    buffer_load_dwordx4 v[160:163], v3, s[48:51], s60 offen
    v_add_u32 v2, 384, v0
    v_mul_u32_u24 v3, 52429, v2
    v_lshrrev_b32 v3, 19, v3
    v_mul_u32_u24 v4, 10, v3
    v_sub_u32 v4, v2, v4
    v_lshlrev_b32 v4, 4, v4
    v_mul_u32_u24 v5, 176, v3
    v_add_u32 v190, v5, v4
    v_mul_u32_u24 v3, 1280, v3
    v_add_u32 v3, v3, v4
    buffer_load_dwordx4 v[164:167], v3, s[48:51], s60 offen
    v_add_u32 v2, 448, v0
    v_mul_u32_u24 v3, 52429, v2
    v_lshrrev_b32 v3, 19, v3
    v_mul_u32_u24 v4, 10, v3
    v_sub_u32 v4, v2, v4
    v_lshlrev_b32 v4, 4, v4
    v_mul_u32_u24 v5, 176, v3
    v_add_u32 v191, v5, v4
    v_mul_u32_u24 v3, 1280, v3
    v_add_u32 v3, v3, v4
    buffer_load_dwordx4 v[168:171], v3, s[48:51], s60 offen
    v_add_u32 v2, 512, v0
    v_mul_u32_u24 v3, 52429, v2
    v_lshrrev_b32 v3, 19, v3
    v_mul_u32_u24 v4, 10, v3
    v_sub_u32 v4, v2, v4
    v_lshlrev_b32 v4, 4, v4
    v_mul_u32_u24 v5, 176, v3
    v_add_u32 v192, v5, v4
    v_mul_u32_u24 v3, 1280, v3
    v_add_u32 v3, v3, v4
    buffer_load_dwordx4 v[172:175], v3, s[48:51], s60 offen
    v_add_u32 v2, 576, v0
    v_mul_u32_u24 v3, 52429, v2
    v_lshrrev_b32 v3, 19, v3
    v_mul_u32_u24 v4, 10, v3
    v_sub_u32 v4, v2, v4
    v_lshlrev_b32 v4, 4, v4
    v_mul_u32_u24 v5, 176, v3
    v_add_u32 v193, v5, v4
    v_mul_u32_u24 v3, 1280, v3
    v_add_u32 v3, v3, v4
    buffer_load_dwordx4 v[176:179], v3, s[48:51], s60 offen
    v_min_u32 v2, 39, v0
    v_lshlrev_b32 v2, 2, v2
    v_add_u32 v2, s61, v2
    global_load_dword v180, v2, s[26:27]
    v_mov_b32 v2, 161776
    s_mov_b32 s61, 0
fused_j6w:
    ds_read_b128 v[4:7], v2
    s_add_u32 s61, s61, 1
    s_waitcnt lgkmcnt(0)
    v_readfirstlane_b32 s60, v4
    s_cmp_gt_u32 s61, 0x200000
    s_cbranch_scc1 fused_j6w_d
    s_cmp_lg_u32 s60, 0
    s_cbranch_scc1 fused_j6w_d
    s_sleep 1
    s_branch fused_j6w
fused_j6w_d:
    s_mul_i32 s66, s40, 10240
    s_add_u32 s66, s66, 16400384
    v_mul_u32_u24 v2, 128, v0
    s_mov_b64 s[62:63], exec
    s_lshr_b64 exec, -1, 24
    s_mov_b32 s64, 0
fused_pfs:
    buffer_load_dword v3, v2, s[44:47], s66 offen offset:0 sc1
    s_add_u32 s65, s66, 5120
    buffer_load_dword v4, v2, s[44:47], s65 offen sc1
    s_add_u32 s64, s64, 1
    s_waitcnt vmcnt(0)
    v_xor_b32 v3, s96, v3
    v_xor_b32 v4, s96, v4
    v_or_b32 v3, v3, v4
    v_cmp_ne_u32 vcc, 0, v3
    s_cmp_gt_u32 s64, 0x20000
    s_cbranch_scc1 fused_pfs_d
    s_cbranch_vccz fused_pfs_d
    s_sleep 3
    s_branch fused_pfs
fused_pfs_d:
    s_mov_b64 exec, s[62:63]
    s_cmp_eq_u32 s41, 0
    s_cbranch_scc1 fused_nocd
    v_mov_b32 v2, 161664
    s_mov_b32 s61, 0
fused_cdw:
    ds_read_b128 v[4:7], v2
    s_add_u32 s61, s61, 1
    s_waitcnt lgkmcnt(0)
    v_min_u32 v4, v4, v5
    s_nop 0
    v_readfirstlane_b32 s60, v4
    s_cmp_gt_u32 s61, 0x200000
    s_cbranch_scc1 fused_cdw_d
    s_cmp_lg_u32 s60, 0
    s_cbranch_scc1 fused_cdw_d
    s_sleep 1
    s_branch fused_cdw
fused_cdw_d:
fused_nocd:
    v_lshrrev_b32 v2, 3, v0
    v_and_b32 v3, 7, v0
    v_lshlrev_b32 v2, 12, v2
    v_lshl_add_u32 v2, v3, 4, v2
    s_mul_i32 s60, s40, 327680
    s_lshl_b32 s61, s39, 7
    s_add_u32 s60, s60, s61
    s_add_u32 s60, s60, 13631488
    s_mov_b32 m0, 122880
    s_nop 0
    buffer_load_dwordx4 v2, s[44:47], s60 offen sc1 lds
    s_add_u32 s60, s60, 32768
    s_mov_b32 m0, 123904
    s_nop 0
    buffer_load_dwordx4 v2, s[44:47], s60 offen sc1 lds
    s_add_u32 s60, s60, 32768
    s_mov_b32 m0, 124928
    s_nop 0
    buffer_load_dwordx4 v2, s[44:47], s60 offen sc1 lds
    s_add_u32 s60, s60, 32768
    s_mov_b32 m0, 125952
    s_nop 0
    buffer_load_dwordx4 v2, s[44:47], s60 offen sc1 lds
    s_add_u32 s60, s60, 32768
    s_mov_b32 m0, 126976
    s_nop 0
    buffer_load_dwordx4 v2, s[44:47], s60 offen sc1 lds
    s_add_u32 s60, s60, 32768
    s_mov_b32 m0, 128000
    s_nop 0
    buffer_load_dwordx4 v2, s[44:47], s60 offen sc1 lds
    s_add_u32 s60, s60, 32768
    s_mov_b32 m0, 129024
    s_nop 0
    buffer_load_dwordx4 v2, s[44:47], s60 offen sc1 lds
    s_add_u32 s60, s60, 32768
    s_mov_b32 m0, 130048
    s_nop 0
    buffer_load_dwordx4 v2, s[44:47], s60 offen sc1 lds
    s_add_u32 s60, s60, 32768
    s_mov_b32 m0, 131072
    s_nop 0
    buffer_load_dwordx4 v2, s[44:47], s60 offen sc1 lds
    s_add_u32 s60, s60, 32768
    s_mov_b32 m0, 132096
    s_nop 0
    buffer_load_dwordx4 v2, s[44:47], s60 offen sc1 lds
    v_add_u32 v184, 135776, v184
    v_add_u32 v185, 135776, v185
    v_add_u32 v186, 135776, v186
    v_add_u32 v187, 135776, v187
    v_add_u32 v188, 135776, v188
    v_add_u32 v189, 135776, v189
    v_add_u32 v190, 135776, v190
    v_add_u32 v191, 135776, v191
    v_add_u32 v192, 135776, v192
    v_add_u32 v193, 135776, v193
    ds_write_b128 v184, v[140:143]
    ds_write_b128 v185, v[144:147]
    ds_write_b128 v186, v[148:151]
    ds_write_b128 v187, v[152:155]
    ds_write_b128 v188, v[156:159]
    ds_write_b128 v189, v[160:163]
    ds_write_b128 v190, v[164:167]
    ds_write_b128 v191, v[168:171]
    ds_write_b128 v192, v[172:175]
    ds_write_b128 v193, v[176:179]
    v_lshlrev_b32 v182, 16, v180
    v_and_b32 v183, 0xffff0000, v180
    v_min_u32 v2, 39, v0
    v_lshlrev_b32 v2, 3, v2
    v_add_u32 v2, 162080, v2
    ds_write_b64 v2, v[182:183]
    s_waitcnt vmcnt(0) lgkmcnt(0)
    s_barrier
fused_end:
    s_endpgm

.section .rodata,"a"
.p2align 6
.amdhsa_kernel recurrent_scan__ssm_conv_s4d__dense_activation_squared_relu__prompt_kernel
  .amdhsa_next_free_vgpr 256
  .amdhsa_next_free_sgpr 102
  .amdhsa_accum_offset 256
  .amdhsa_group_segment_fixed_size 0
  .amdhsa_kernarg_size 120
  .amdhsa_user_sgpr_count 2
  .amdhsa_user_sgpr_kernarg_segment_ptr 1
  .amdhsa_system_sgpr_workgroup_id_x 1
.end_amdhsa_kernel
```
